```python
import torch

def _softmax(x, axis=-1):
    return torch.softmax(x, dim=axis)
def _gelu(x):
    return torch.nn.functional.gelu(x, approximate="tanh")
def _silu(x):
    return torch.nn.functional.silu(x)
def _sigmoid(x):
    return torch.sigmoid(x)
def _layernorm(x, axis=-1, eps=1e-5):
    m = x.mean(dim=axis, keepdim=True)
    v = x.var(dim=axis, keepdim=True, unbiased=False)
    return (x - m) / torch.sqrt(v + eps)
def _scatter_add(tgt, idx, src, axis=0):
    return tgt.clone().index_add_(axis, idx, src)
def _segment_sum(src, seg, n):
    out = torch.zeros((n,) + src.shape[1:], dtype=src.dtype)
    return out.index_add_(0, seg, src)
def _pad(x, pw):
    flat = tuple(v for pair in reversed(pw) for v in pair)
    return torch.nn.functional.pad(x, flat)

kernel_name = 'gated_mix__spectral_gfnet__dense_activation_gelu__prompt'

def setup_inputs():

    _w = (lambda a: (lambda t: t.to(torch.bfloat16) if t.is_floating_point() else t)(torch.as_tensor(a)))
    def _A_setup():
        B, S, D = 1, 2048, 512
        Df = D // 2 + 1
        return {
            "x": _w((lambda *s: torch.randn(*s, dtype=torch.bfloat16) * 0.05)(B, S, D)),
            "w_r": _w((lambda *s: torch.randn(*s, dtype=torch.bfloat16) * 0.8)(S, Df) * 0.02),
            "w_i": _w((lambda *s: torch.randn(*s, dtype=torch.bfloat16) * 0.8)(S, Df) * 0.02),
        }
    _A_in = _A_setup()

    def _B_setup():
        B, S, D, F = 1, 2048, 512, 1792
        return {
            "x": _w((lambda *s: torch.randn(*s, dtype=torch.bfloat16) * 0.05)(B, S, D)),
            "w1": _w((lambda *s: torch.randn(*s, dtype=torch.bfloat16) * 3.2)(D, F) * (D ** -0.5)),
            "b1": _w((lambda *s: torch.randn(*s, dtype=torch.bfloat16) * 3.2)(F) * 0.01),
            "w2": _w((lambda *s: torch.randn(*s, dtype=torch.bfloat16) * 0.05)(F, D) * (F ** -0.5)),
            "b2": _w((lambda *s: torch.randn(*s, dtype=torch.bfloat16) * 0.1)(D) * 0.01),
        }
    _B_in = _B_setup()

    return {
        "A_x": _A_in["x"],
        "A_w_r": _A_in["w_r"],
        "A_w_i": _A_in["w_i"],
        "B_x": _B_in["x"],
        "B_w1": _B_in["w1"],
        "B_b1": _B_in["b1"],
        "B_w2": _B_in["w2"],
        "B_b2": _B_in["b2"],
        "gate_w": _w((lambda *s: torch.randn(*s, dtype=torch.bfloat16) * 0.05)(512) * 16.0),
    }

def reference(A_x, A_w_r, A_w_i, B_x, B_w1, B_b1, B_w2, B_b2, gate_w):
    def _A_ref(x, w_r, w_i):
        B, S, D = x.shape
        X = (lambda x, axes=(-2,-1): torch.fft.rfft2(x.float(), dim=axes))(x, axes=(-2, -1))
        W = w_r + 1j * w_i
        X = X * W
        y = (lambda x, s, axes=(-2,-1): torch.fft.irfft2(x, s=s, dim=axes).to(torch.bfloat16))(X, (S, D), axes=(-2, -1))
        return y

    def _B_ref(x, w1, b1, w2, b2):
        h = torch.einsum("bsd,df->bsf", x, w1) + b1
        h = _gelu(h)
        return torch.einsum("bsf,fd->bsd", h, w2) + b2

    x = A_x
    g = _sigmoid((x * gate_w).sum(-1, keepdims=True))
    a = _A_ref(x, A_w_r, A_w_i)
    b = _B_ref(x, B_w1, B_b1, B_w2, B_b2)
    return g * a + (1 - g) * b
```

```asm
; @launch grid=(256,1,1) block=(256,1,1) lds=163840
.amdgcn_target "amdgcn-amd-amdhsa--gfx950"
.text
.globl gated_mix__spectral_gfnet__dense_activation_gelu__prompt_kernel
.p2align 8
.type gated_mix__spectral_gfnet__dense_activation_gelu__prompt_kernel,@function
gated_mix__spectral_gfnet__dense_activation_gelu__prompt_kernel:
    s_cmp_ge_u32 s2, 256
    s_cbranch_scc1 L_end
    s_load_dwordx2 s[4:5], s[0:1], 0
    s_lshr_b32 s50, s2, 3
    s_getpc_b64 s[72:73]
L_pc:
    s_mov_b32 s74, L_code_end-L_pc
    s_mov_b32 s75, 0x00020000
    s_lshl_b32 s76, s50, 10
    v_and_b32 v22, 7, v0
    v_lshlrev_b32 v22, 7, v22
    buffer_load_dword v21, v22, s[72:75], s76 offen
    v_lshrrev_b32 v3, 6, v0
    v_and_b32 v0, 63, v0
    v_readfirstlane_b32 s48, v3
    v_lshrrev_b32 v2, 4, v0
    s_bfe_u32 s69, s2, 0x20001
    s_lshr_b32 s67, s2, 6
    s_lshl2_add_u32 s51, s69, s67
    s_xor_b32 s67, s67, s50
    s_lshl2_add_u32 s67, s67, s69
    s_and_b32 s66, s2, 1
    s_lshl1_add_u32 s67, s66, s67
    s_and_b32 s53, s67, 7
    s_lshr_b32 s68, s48, 1
    s_lshl1_add_u32 s54, s51, s68
    s_and_b32 s55, s48, 1
    s_mov_b32 s6, 2097152
    s_mov_b32 s7, 0x00020000
    s_lshl_b32 s66, s55, 5
    s_add_u32 s66, s66, s54
    s_lshl_b32 s66, s66, 10
    v_lshrrev_b32 v22, 3, v0
    v_and_b32 v23, 7, v0
    v_xor_b32 v23, v23, v2
    v_lshl_add_u32 v22, v22, 12, v23
    v_lshl_add_u32 v4, v22, 4, s66
    v_xor_b32 v22, 64, v4
    v_add_u32 v5, 523264, v22
    v_add_u32 v6, 1046528, v4
    v_add_u32 v7, 1046528, v5
    s_mul_i32 s59, s48, 12288
    s_lshl_b32 s57, s53, 7
    s_waitcnt lgkmcnt(0)
    s_load_dwordx2 s[12:13], s[0:1], 32
    s_add_u32 m0, s59, 0
    s_nop 0
    buffer_load_dwordx4 v4, s[4:7], s57 offen offset:0  lds
    buffer_load_dwordx4 v5, s[4:7], s57 offen offset:1024  lds
    buffer_load_dwordx4 v6, s[4:7], s57 offen offset:2048  lds
    buffer_load_dwordx4 v7, s[4:7], s57 offen offset:3072  lds
    s_add_u32 s57, s57, 128
    s_and_b32 s57, s57, 1023
    s_and_b32 s49, s2, 7
    s_and_b32 s66, s2, 1
    s_and_b32 s67, s50, 7
    s_lshl3_add_u32 s52, s66, s67
    s_and_b32 s56, s52, 1
    v_and_b32 v1, 15, v0
    v_lshlrev_b32 v3, 4, v0
    s_mov_b32 s14, 1835008
    s_mov_b32 s15, 0x00020000
    s_mul_i32 s66, s52, 224
    s_and_b32 s66, s66, 0xffffffc0
    s_mul_i32 s67, s48, 57344
    s_add_u32 s66, s66, s67
    v_mul_u32_u24 v22, 3584, v2
    v_add_u32 v22, s66, v22
    v_lshlrev_b32 v23, 1, v2
    v_xor_b32 v23, v23, v1
    v_lshlrev_b32 v23, 4, v23
    v_xor_b32 v24, 128, v23
    v_add_u32 v8, v22, v23
    v_add_u32 v9, 13312, v8
    v_add_u32 v22, 26624, v22
    v_add_u32 v10, v22, v24
    v_add_u32 v11, 13312, v10
    s_lshl_b32 s60, s48, 12
    s_add_u32 s60, s60, 49152
    s_mul_i32 s58, s53, 229376
    s_waitcnt lgkmcnt(0)
    s_add_u32 m0, s60, 0
    s_nop 0
    buffer_load_dwordx4 v8, s[12:15], s58 offen offset:0  lds
    buffer_load_dwordx4 v9, s[12:15], s58 offen offset:1024  lds
    buffer_load_dwordx4 v10, s[12:15], s58 offen offset:2048  lds
    buffer_load_dwordx4 v11, s[12:15], s58 offen offset:3072  lds
    s_add_u32 s58, s58, 229376
    s_cmp_eq_u32 s58, 1835008
    s_cselect_b32 s58, 0, s58
    s_load_dwordx2 s[8:9], s[0:1], 88
    s_load_dwordx2 s[24:25], s[0:1], 48
    s_load_dwordx2 s[28:29], s[0:1], 40
    s_load_dwordx2 s[36:37], s[0:1], 64
    s_load_dwordx2 s[16:17], s[0:1], 8
    s_load_dwordx2 s[20:21], s[0:1], 16
    s_load_dwordx2 s[32:33], s[0:1], 56
    s_load_dwordx2 s[40:41], s[0:1], 72
    s_load_dwordx2 s[44:45], s[0:1], 80
    s_mov_b32 s10, 268435456
    s_mov_b32 s11, 0x00020000
    s_mov_b32 s26, 1835008
    s_mov_b32 s27, 0x00020000
    s_mov_b32 s30, 3584
    s_mov_b32 s31, 0x00020000
    s_mov_b32 s38, 1024
    s_mov_b32 s39, 0x00020000
    s_mov_b32 s18, 1052672
    s_mov_b32 s19, 0x00020000
    s_mov_b32 s22, 1052672
    s_mov_b32 s23, 0x00020000
    s_mov_b32 s34, 1024
    s_mov_b32 s35, 0x00020000
    s_mov_b32 s42, 2097152
    s_mov_b32 s43, 0x00020000
    s_mov_b32 s46, 256
    s_mov_b32 s47, 0x00020000
    s_waitcnt lgkmcnt(0)
    s_or_b32 s78, s2, s48
    s_cmp_lg_u32 s78, 0
    s_cbranch_scc1 L_notag_1
    s_mov_b32 s3, 0x9e3779b1
    s_mov_b32 s78, 18350080
    s_atomic_add s3, s[8:9], s78 glc
L_notag_1:
    s_lshr_b32 s74, s2, 2
    s_lshl_b32 s74, s74, 15
    s_and_b32 s75, s2, 3
    s_lshl_b32 s75, s75, 8
    s_add_u32 s74, s74, s75
    s_lshl_b32 s75, s48, 6
    s_add_u32 s74, s74, s75
    s_add_u32 s75, s74, 15360
    v_lshrrev_b32 v32, 2, v0
    v_and_b32 v33, 3, v0
    v_lshlrev_b32 v33, 4, v33
    v_lshl_add_u32 v32, v32, 10, v33
    s_lshl_b32 s76, s48, 11
    s_add_u32 m0, s76, 147456
    s_nop 0
    buffer_load_dwordx4 v32, s[24:27], s74 offen  lds
    buffer_load_dwordx4 v32, s[24:27], s75 offen offset:1024  lds
    s_mul_i32 s66, s52, 224
    s_lshl_b32 s67, s48, 8
    s_add_u32 m0, s67, 155648
    v_lshlrev_b32 v22, 2, v0
    buffer_load_dword v22, s[28:31], s66 offen lds
    s_lshl_b32 s66, s49, 2
    s_bfe_u32 s67, s50, 0x20002
    s_add_u32 s66, s66, s67
    s_lshr_b32 s67, s50, 4
    s_lshl_b32 s67, s67, 5
    s_add_u32 s61, s66, s67
    s_and_b32 s62, s50, 3
    s_and_b32 s66, s52, 3
    s_lshr_b32 s67, s52, 2
    s_lshl_b32 s67, s67, 6
    s_add_u32 s66, s66, s67
    v_lshl_add_u32 v22, v1, 2, s66
    v_cvt_f32_u32 v22, v22
    v_mul_f32 v22, 0x3b000000, v22
    s_lshl_b32 s66, s53, 6
    s_lshl_b32 s67, s48, 5
    s_add_u32 s66, s66, s67
    v_lshl_add_u32 v23, v2, 3, s66
    v_cvt_f32_u32 v23, v23
    v_mul_f32 v23, v23, v22
    v_fract_f32 v23, v23
    s_lshl_b32 s66, s48, 10
    s_add_u32 s66, s66, 131072
    v_cos_f32 v26, v23
    v_sin_f32 v27, v23
    v_add_f32 v34, v23, v22
    v_add_f32 v35, v22, v22
    v_cos_f32 v28, v34
    v_sin_f32 v29, v34
    v_cos_f32 v30, v35
    v_sin_f32 v31, v35
    v_cvt_pk_bf16_f32 v38, v26, v28
    v_cvt_pk_bf16_f32 v42, -v27, -v29
    v_pk_mul_f32 v[34:35], v[26:27], v[30:31] op_sel_hi:[1,0]
    v_pk_mul_f32 v[36:37], v[28:29], v[30:31] op_sel_hi:[1,0]
    v_pk_fma_f32 v[26:27], v[26:27], v[30:31], v[34:35] op_sel:[1,1,0] op_sel_hi:[0,1,1] neg_lo:[1,0,0]
    v_pk_fma_f32 v[28:29], v[28:29], v[30:31], v[36:37] op_sel:[1,1,0] op_sel_hi:[0,1,1] neg_lo:[1,0,0]
    v_cvt_pk_bf16_f32 v39, v26, v28
    v_cvt_pk_bf16_f32 v43, -v27, -v29
    v_pk_mul_f32 v[34:35], v[26:27], v[30:31] op_sel_hi:[1,0]
    v_pk_mul_f32 v[36:37], v[28:29], v[30:31] op_sel_hi:[1,0]
    v_pk_fma_f32 v[26:27], v[26:27], v[30:31], v[34:35] op_sel:[1,1,0] op_sel_hi:[0,1,1] neg_lo:[1,0,0]
    v_pk_fma_f32 v[28:29], v[28:29], v[30:31], v[36:37] op_sel:[1,1,0] op_sel_hi:[0,1,1] neg_lo:[1,0,0]
    v_cvt_pk_bf16_f32 v40, v26, v28
    v_cvt_pk_bf16_f32 v44, -v27, -v29
    v_pk_mul_f32 v[34:35], v[26:27], v[30:31] op_sel_hi:[1,0]
    v_pk_mul_f32 v[36:37], v[28:29], v[30:31] op_sel_hi:[1,0]
    v_pk_fma_f32 v[26:27], v[26:27], v[30:31], v[34:35] op_sel:[1,1,0] op_sel_hi:[0,1,1] neg_lo:[1,0,0]
    v_pk_fma_f32 v[28:29], v[28:29], v[30:31], v[36:37] op_sel:[1,1,0] op_sel_hi:[0,1,1] neg_lo:[1,0,0]
    v_cvt_pk_bf16_f32 v41, v26, v28
    v_cvt_pk_bf16_f32 v45, -v27, -v29
    s_cmp_lg_u32 s52, 0
    s_cbranch_scc1 L_nony_2
    v_cmp_eq_u32 vcc, 0, v1
    v_mov_b32 v24, 0xbf803f80
    s_nop 0
    v_cndmask_b32 v42, v42, v24, vcc
    v_cndmask_b32 v43, v43, v24, vcc
    v_cndmask_b32 v44, v44, v24, vcc
    v_cndmask_b32 v45, v45, v24, vcc
L_nony_2:
    v_add_u32 v22, s66, v3
    ds_write_b128 v22, v[38:41]
    ds_write_b128 v22, v[42:45] offset:4096
    s_add_u32 m0, s59, 4096
    s_nop 0
    buffer_load_dwordx4 v4, s[4:7], s57 offen offset:0  lds
    buffer_load_dwordx4 v5, s[4:7], s57 offen offset:1024  lds
    buffer_load_dwordx4 v6, s[4:7], s57 offen offset:2048  lds
    buffer_load_dwordx4 v7, s[4:7], s57 offen offset:3072  lds
    s_add_u32 s57, s57, 128
    s_and_b32 s57, s57, 1023
    v_lshrrev_b32 v22, 1, v1
    v_xor_b32 v22, v22, v2
    v_lshlrev_b32 v22, 4, v22
    v_lshl_add_u32 v22, v1, 7, v22
    v_add_u32 v12, s59, v22
    v_xor_b32 v13, 64, v12
    v_bfe_u32 v22, v0, 2, 2
    v_and_b32 v23, 1, v2
    v_lshl_or_b32 v23, v23, 2, v22
    v_lshl_add_u32 v22, v2, 3, v22
    v_lshlrev_b32 v22, 8, v22
    v_and_b32 v24, 3, v0
    v_lshl_add_u32 v22, v24, 3, v22
    v_add_u32 v22, 49152, v22
    s_lshl_b32 s66, s56, 1
    v_xor_b32 v24, s66, v23
    v_lshl_add_u32 v14, v24, 5, v22
    s_add_u32 s66, s66, 1
    v_xor_b32 v24, s66, v23
    v_lshl_add_u32 v15, v24, 5, v22
    s_add_u32 s66, s66, 1
    v_xor_b32 v24, s66, v23
    v_lshl_add_u32 v16, v24, 5, v22
    s_add_u32 s66, s66, 1
    v_xor_b32 v24, s66, v23
    v_lshl_add_u32 v17, v24, 5, v22
    s_add_u32 s66, s66, 1
    v_xor_b32 v24, s66, v23
    v_lshl_add_u32 v18, v24, 5, v22
    s_add_u32 s66, s66, 1
    v_xor_b32 v24, s66, v23
    v_lshl_add_u32 v19, v24, 5, v22
    s_cmp_eq_u32 s56, 0
    s_cselect_b32 s66, 6, 1
    v_xor_b32 v24, s66, v23
    v_lshl_add_u32 v20, v24, 5, v22
    v_add_u32 v22, 131072, v3
    s_waitcnt lgkmcnt(0)
    s_barrier
    ds_read_b128 v[224:227], v22 offset:0
    ds_read_b128 v[228:231], v22 offset:1024
    ds_read_b128 v[232:235], v22 offset:2048
    ds_read_b128 v[236:239], v22 offset:3072
    ds_read_b128 v[240:243], v22 offset:4096
    ds_read_b128 v[244:247], v22 offset:5120
    ds_read_b128 v[248:251], v22 offset:6144
    ds_read_b128 v[252:255], v22 offset:7168
    s_or_b32 s78, s2, s48
    s_cmp_lg_u32 s78, 0
    s_cbranch_scc1 L_nopub_3
    s_waitcnt lgkmcnt(0)
    s_add_u32 s98, s3, 0x9e3779b1
    s_max_u32 s98, s98, 1
    s_atomic_add s98, s[44:45], 0x0 glc
L_nopub_3:
    s_add_u32 m0, s60, 16384
    s_nop 0
    buffer_load_dwordx4 v8, s[12:15], s58 offen offset:0  lds
    buffer_load_dwordx4 v9, s[12:15], s58 offen offset:1024  lds
    buffer_load_dwordx4 v10, s[12:15], s58 offen offset:2048  lds
    buffer_load_dwordx4 v11, s[12:15], s58 offen offset:3072  lds
    s_add_u32 s58, s58, 229376
    s_cmp_eq_u32 s58, 1835008
    s_cselect_b32 s58, 0, s58
    v_cvt_f32_u32 v22, v1
    v_mul_f32 v22, 0x3d000000, v22
    v_lshlrev_b32 v23, 2, v2
    v_cvt_f32_u32 v23, v23
    v_mul_f32 v23, v23, v22
    v_and_b32 v24, 1, v1
    v_mul_u32_u24 v24, 0x8000, v24
    v_lshl_or_b32 v24, v24, 16, v24
    v_cos_f32 v26, v23
    v_sin_f32 v28, v23
    v_add_f32 v23, v23, v22
    v_cos_f32 v27, v23
    v_sin_f32 v29, v23
    v_cvt_pk_bf16_f32 v208, v26, v27
    v_cvt_pk_bf16_f32 v216, v28, v29
    v_xor_b32 v210, v24, v208
    v_xor_b32 v212, 0x80000000, v208
    v_xor_b32 v214, 0x80000000, v210
    v_xor_b32 v218, v24, v216
    v_xor_b32 v220, 0x80000000, v216
    v_xor_b32 v222, 0x80000000, v218
    v_add_f32 v23, v23, v22
    v_cos_f32 v26, v23
    v_sin_f32 v28, v23
    v_add_f32 v23, v23, v22
    v_cos_f32 v27, v23
    v_sin_f32 v29, v23
    v_cvt_pk_bf16_f32 v209, v26, v27
    v_cvt_pk_bf16_f32 v217, v28, v29
    v_xor_b32 v211, v24, v209
    v_xor_b32 v213, 0x80000000, v209
    v_xor_b32 v215, 0x80000000, v211
    v_xor_b32 v219, v24, v217
    v_xor_b32 v221, 0x80000000, v217
    v_xor_b32 v223, 0x80000000, v219
    s_lshr_b32 s74, s2, 2
    s_mul_i32 s75, s74, 37
    s_lshr_b32 s75, s75, 8
    s_mul_i32 s75, s75, 7
    s_sub_u32 s75, s74, s75
    v_lshlrev_b32 v44, 2, v2
    v_and_b32 v45, 1, v2
    v_lshlrev_b32 v45, 2, v45
    v_and_b32 v46, 2, v2
    v_lshl_add_u32 v45, v46, 3, v45
    s_cmp_eq_u32 s75, 3
    s_cselect_b64 vcc, -1, 0
    s_cselect_b32 s75, 1, 2
    s_lshl_b32 s75, s75, 9
    v_cndmask_b32 v44, v44, v45, vcc
    v_bfe_u32 v45, v0, 2, 2
    v_add_u32 v44, v44, v45
    v_and_b32 v45, 3, v0
    v_lshlrev_b32 v45, 3, v45
    v_lshl_add_u32 v44, v44, 6, v45
    s_lshl_b32 s76, s48, 11
    s_add_u32 s76, s76, 147456
    v_add_u32 v44, s76, v44
    v_add_u32 v45, s75, v44
    s_mul_i32 s75, s48, 458752
    s_lshl_b32 s76, s2, 10
    s_add_u32 s75, s75, s76
    s_add_u32 s75, s75, 8388608
    s_add_u32 s76, s75, 229376
    s_cmp_ge_u32 s2, 224
    s_cselect_b32 s75, 268435456, s75
    s_cselect_b32 s76, 268435456, s76
    s_waitcnt vmcnt(9)
    ds_read_b64_tr_b16 v[46:47], v44 offset:0
    ds_read_b64_tr_b16 v[48:49], v45 offset:0
    ds_read_b64_tr_b16 v[50:51], v44 offset:32
    ds_read_b64_tr_b16 v[52:53], v45 offset:32
    s_waitcnt vmcnt(8)
    s_lshl_b32 s66, s48, 8
    s_add_u32 s66, s66, 155648
    s_lshl_b32 s67, s56, 5
    s_add_u32 s67, s66, s67
    s_cmp_eq_u32 s56, 0
    s_cselect_b32 s68, 192, 0
    s_add_u32 s68, s66, s68
    v_lshl_add_u32 v42, v2, 3, s67
    v_lshl_add_u32 v43, v2, 3, s68
    ds_read_b64 v[60:61], v42 offset:0
    ds_read_b64 v[68:69], v42 offset:32
    ds_read_b64 v[76:77], v42 offset:64
    ds_read_b64 v[84:85], v42 offset:96
    ds_read_b64 v[92:93], v42 offset:128
    ds_read_b64 v[100:101], v42 offset:160
    ds_read_b64 v[108:109], v43 offset:0
    s_add_u32 m0, s59, 8192
    s_nop 0
    buffer_load_dwordx4 v4, s[4:7], s57 offen offset:0  lds
    buffer_load_dwordx4 v5, s[4:7], s57 offen offset:1024  lds
    buffer_load_dwordx4 v6, s[4:7], s57 offen offset:2048  lds
    buffer_load_dwordx4 v7, s[4:7], s57 offen offset:3072  lds
    s_add_u32 s57, s57, 128
    s_and_b32 s57, s57, 1023
    v_and_b32 v26, 31, v0
    v_lshl_add_u32 v26, v26, 6, s61
    v_sub_u32 v27, 2048, v26
    v_and_b32 v27, 2047, v27
    v_mul_u32_u24 v26, 514, v26
    v_mul_u32_u24 v27, 514, v27
    s_mul_i32 s24, s61, 514
    s_lshl_b32 s25, s62, 1
    s_add_u32 s24, s24, s25
    s_lshl_b32 s25, s48, 7
    s_add_u32 s24, s24, s25
    s_or_b32 s25, s62, s48
    v_mul_u32_u24 v28, 131584, v2
    v_lshl_add_u32 v28, v1, 3, v28
    s_lshl_b32 s77, s52, 1
    s_lshl_b32 s78, s55, 5
    s_lshl_b32 s99, s54, 6
    s_add_u32 s99, s99, s78
    s_add_u32 s99, s99, s77
    s_lshl_b32 s99, s99, 2
    s_add_u32 s99, s99, 16777216
    s_lshl_b32 s77, s77, 6
    s_add_u32 s77, s77, s78
    s_add_u32 s77, s77, s54
    s_lshl_b32 s77, s77, 10
    s_add_u32 s78, s77, 65536
    s_waitcnt lgkmcnt(0)
    v_lshlrev_b32 v56, 16, v60
    v_and_b32 v57, 0xffff0000, v60
    v_lshlrev_b32 v58, 16, v61
    v_and_b32 v59, 0xffff0000, v61
    v_lshlrev_b32 v64, 16, v68
    v_and_b32 v65, 0xffff0000, v68
    v_lshlrev_b32 v66, 16, v69
    v_and_b32 v67, 0xffff0000, v69
    v_lshlrev_b32 v72, 16, v76
    v_and_b32 v73, 0xffff0000, v76
    v_lshlrev_b32 v74, 16, v77
    v_and_b32 v75, 0xffff0000, v77
    v_lshlrev_b32 v80, 16, v84
    v_and_b32 v81, 0xffff0000, v84
    v_lshlrev_b32 v82, 16, v85
    v_and_b32 v83, 0xffff0000, v85
    v_lshlrev_b32 v88, 16, v92
    v_and_b32 v89, 0xffff0000, v92
    v_lshlrev_b32 v90, 16, v93
    v_and_b32 v91, 0xffff0000, v93
    v_lshlrev_b32 v96, 16, v100
    v_and_b32 v97, 0xffff0000, v100
    v_lshlrev_b32 v98, 16, v101
    v_and_b32 v99, 0xffff0000, v101
    v_lshlrev_b32 v104, 16, v108
    v_and_b32 v105, 0xffff0000, v108
    v_lshlrev_b32 v106, 16, v109
    v_and_b32 v107, 0xffff0000, v109
    ds_read_b128 a[0:3], v12 offset:0
    ds_read_b128 a[4:7], v12 offset:2048
    ds_read_b128 a[8:11], v13 offset:0
    ds_read_b128 a[12:15], v13 offset:2048
    s_waitcnt lgkmcnt(0)
    s_waitcnt vmcnt(8)
    v_mfma_f32_16x16x32_bf16 v[112:115], a[0:3], v[224:227], 0
    ds_read_b128 a[16:19], v12 offset:4096
    v_mfma_f32_16x16x32_bf16 v[116:119], a[0:3], v[240:243], 0
    ds_read_b128 a[20:23], v12 offset:6144
    v_mfma_f32_16x16x32_bf16 v[120:123], a[4:7], v[224:227], 0
    ds_read_b128 a[24:27], v13 offset:4096
    s_add_u32 m0, s59, 0
    s_nop 0
    buffer_load_dwordx4 v4, s[4:7], s57 offen offset:0  lds
    v_mfma_f32_16x16x32_bf16 v[124:127], a[4:7], v[240:243], 0
    ds_read_b128 a[28:31], v13 offset:6144
    v_mfma_f32_16x16x32_bf16 v[112:115], a[8:11], v[228:231], v[112:115]
    v_mfma_f32_16x16x32_bf16 v[116:119], a[8:11], v[244:247], v[116:119]
    v_mfma_f32_16x16x32_bf16 v[120:123], a[12:15], v[228:231], v[120:123]
    buffer_load_dwordx4 v5, s[4:7], s57 offen offset:1024  lds
    v_mfma_f32_16x16x32_bf16 v[124:127], a[12:15], v[244:247], v[124:127]
    s_waitcnt lgkmcnt(0)
    s_barrier
    v_mfma_f32_16x16x32_bf16 v[112:115], a[16:19], v[232:235], v[112:115]
    ds_read_b64_tr_b16 a[128:129], v14 offset:0
    ds_read_b64_tr_b16 a[130:131], v14 offset:1024
    v_mfma_f32_16x16x32_bf16 v[116:119], a[16:19], v[248:251], v[116:119]
    ds_read_b64_tr_b16 a[132:133], v15 offset:0
    ds_read_b64_tr_b16 a[134:135], v15 offset:1024
    v_mfma_f32_16x16x32_bf16 v[120:123], a[20:23], v[232:235], v[120:123]
    ds_read_b64_tr_b16 a[136:137], v16 offset:0
    ds_read_b64_tr_b16 a[138:139], v16 offset:1024
    buffer_load_dwordx4 v6, s[4:7], s57 offen offset:2048  lds
    v_mfma_f32_16x16x32_bf16 v[124:127], a[20:23], v[248:251], v[124:127]
    ds_read_b64_tr_b16 a[140:141], v17 offset:0
    v_mfma_f32_16x16x32_bf16 v[112:115], a[24:27], v[236:239], v[112:115]
    ds_read_b64_tr_b16 a[142:143], v17 offset:1024
    ds_read_b64_tr_b16 a[144:145], v18 offset:0
    v_mfma_f32_16x16x32_bf16 v[116:119], a[24:27], v[252:255], v[116:119]
    ds_read_b64_tr_b16 a[146:147], v18 offset:1024
    ds_read_b64_tr_b16 a[148:149], v19 offset:0
    v_mfma_f32_16x16x32_bf16 v[120:123], a[28:31], v[236:239], v[120:123]
    ds_read_b64_tr_b16 a[150:151], v19 offset:1024
    ds_read_b64_tr_b16 a[152:153], v20 offset:0
    buffer_load_dwordx4 v7, s[4:7], s57 offen offset:3072  lds
    s_add_u32 s57, s57, 128
    s_and_b32 s57, s57, 1023
    v_mfma_f32_16x16x32_bf16 v[124:127], a[28:31], v[252:255], v[124:127]
    ds_read_b64_tr_b16 a[154:155], v20 offset:1024
    s_waitcnt lgkmcnt(6)
    v_mfma_f32_16x16x32_bf16 v[60:63], a[128:131], a[4:7], v[56:59]
    ds_read_b64_tr_b16 a[156:157], v14 offset:8192
    v_mfma_f32_16x16x32_bf16 v[56:59], a[128:131], a[0:3], v[56:59]
    ds_read_b64_tr_b16 a[158:159], v14 offset:9216
    s_add_u32 m0, s59, 4096
    s_nop 0
    buffer_load_dwordx4 v4, s[4:7], s57 offen offset:0  lds
    v_mfma_f32_16x16x32_bf16 v[68:71], a[132:135], a[4:7], v[64:67]
    ds_read_b64_tr_b16 a[160:161], v15 offset:8192
    v_mfma_f32_16x16x32_bf16 v[64:67], a[132:135], a[0:3], v[64:67]
    ds_read_b64_tr_b16 a[162:163], v15 offset:9216
    v_mfma_f32_16x16x32_bf16 v[76:79], a[136:139], a[4:7], v[72:75]
    ds_read_b64_tr_b16 a[164:165], v16 offset:8192
    v_mfma_f32_16x16x32_bf16 v[72:75], a[136:139], a[0:3], v[72:75]
    ds_read_b64_tr_b16 a[166:167], v16 offset:9216
    buffer_load_dwordx4 v5, s[4:7], s57 offen offset:1024  lds
    v_mfma_f32_16x16x32_bf16 v[84:87], a[140:143], a[4:7], v[80:83]
    ds_read_b64_tr_b16 a[168:169], v17 offset:8192
    v_mfma_f32_16x16x32_bf16 v[80:83], a[140:143], a[0:3], v[80:83]
    ds_read_b64_tr_b16 a[170:171], v17 offset:9216
    s_waitcnt lgkmcnt(8)
    v_mfma_f32_16x16x32_bf16 v[92:95], a[144:147], a[4:7], v[88:91]
    ds_read_b64_tr_b16 a[172:173], v18 offset:8192
    buffer_load_dwordx4 v6, s[4:7], s57 offen offset:2048  lds
    v_mfma_f32_16x16x32_bf16 v[88:91], a[144:147], a[0:3], v[88:91]
    ds_read_b64_tr_b16 a[174:175], v18 offset:9216
    v_mfma_f32_16x16x32_bf16 v[100:103], a[148:151], a[4:7], v[96:99]
    ds_read_b64_tr_b16 a[176:177], v19 offset:8192
    v_mfma_f32_16x16x32_bf16 v[96:99], a[148:151], a[0:3], v[96:99]
    ds_read_b64_tr_b16 a[178:179], v19 offset:9216
    v_mfma_f32_16x16x32_bf16 v[108:111], a[152:155], a[4:7], v[104:107]
    ds_read_b64_tr_b16 a[180:181], v20 offset:8192
    buffer_load_dwordx4 v7, s[4:7], s57 offen offset:3072  lds
    s_add_u32 s57, s57, 128
    s_and_b32 s57, s57, 1023
    v_mfma_f32_16x16x32_bf16 v[104:107], a[152:155], a[0:3], v[104:107]
    ds_read_b64_tr_b16 a[182:183], v20 offset:9216
    s_waitcnt vmcnt(8)
    s_waitcnt lgkmcnt(6)
    v_mfma_f32_16x16x32_bf16 v[60:63], a[156:159], a[12:15], v[60:63]
    ds_read_b128 a[32:35], v12 offset:8192
    v_mfma_f32_16x16x32_bf16 v[56:59], a[156:159], a[8:11], v[56:59]
    ds_read_b128 a[36:39], v12 offset:10240
    s_add_u32 m0, s60, 32768
    s_nop 0
    buffer_load_dwordx4 v8, s[12:15], s58 offen offset:0  lds
    v_mfma_f32_16x16x32_bf16 v[68:71], a[160:163], a[12:15], v[68:71]
    ds_read_b128 a[40:43], v13 offset:8192
    v_mfma_f32_16x16x32_bf16 v[64:67], a[160:163], a[8:11], v[64:67]
    ds_read_b128 a[44:47], v13 offset:10240
    v_mfma_f32_16x16x32_bf16 v[76:79], a[164:167], a[12:15], v[76:79]
    v_mfma_f32_16x16x32_bf16 v[72:75], a[164:167], a[8:11], v[72:75]
    buffer_load_dwordx4 v9, s[12:15], s58 offen offset:1024  lds
    v_mfma_f32_16x16x32_bf16 v[84:87], a[168:171], a[12:15], v[84:87]
    v_mfma_f32_16x16x32_bf16 v[80:83], a[168:171], a[8:11], v[80:83]
    s_waitcnt lgkmcnt(4)
    v_mfma_f32_16x16x32_bf16 v[92:95], a[172:175], a[12:15], v[92:95]
    buffer_load_dwordx4 v10, s[12:15], s58 offen offset:2048  lds
    v_mfma_f32_16x16x32_bf16 v[88:91], a[172:175], a[8:11], v[88:91]
    v_mfma_f32_16x16x32_bf16 v[100:103], a[176:179], a[12:15], v[100:103]
    v_mfma_f32_16x16x32_bf16 v[96:99], a[176:179], a[8:11], v[96:99]
    v_mfma_f32_16x16x32_bf16 v[108:111], a[180:183], a[12:15], v[108:111]
    buffer_load_dwordx4 v11, s[12:15], s58 offen offset:3072  lds
    s_add_u32 s58, s58, 229376
    s_cmp_eq_u32 s58, 1835008
    s_cselect_b32 s58, 0, s58
    v_mfma_f32_16x16x32_bf16 v[104:107], a[180:183], a[8:11], v[104:107]
    s_waitcnt lgkmcnt(0)
    s_waitcnt vmcnt(8)
    v_mfma_f32_16x16x32_bf16 v[128:131], a[32:35], v[224:227], 0
    ds_read_b128 a[48:51], v12 offset:0
    v_mfma_f32_16x16x32_bf16 v[132:135], a[32:35], v[240:243], 0
    ds_read_b128 a[52:55], v12 offset:2048
    v_mfma_f32_16x16x32_bf16 v[136:139], a[36:39], v[224:227], 0
    ds_read_b128 a[56:59], v13 offset:0
    s_add_u32 m0, s59, 8192
    s_nop 0
    buffer_load_dwordx4 v4, s[4:7], s57 offen offset:0  lds
    v_mfma_f32_16x16x32_bf16 v[140:143], a[36:39], v[240:243], 0
    ds_read_b128 a[60:63], v13 offset:2048
    v_mfma_f32_16x16x32_bf16 v[128:131], a[40:43], v[228:231], v[128:131]
    v_mfma_f32_16x16x32_bf16 v[132:135], a[40:43], v[244:247], v[132:135]
    v_mfma_f32_16x16x32_bf16 v[136:139], a[44:47], v[228:231], v[136:139]
    buffer_load_dwordx4 v5, s[4:7], s57 offen offset:1024  lds
    v_mfma_f32_16x16x32_bf16 v[140:143], a[44:47], v[244:247], v[140:143]
    s_waitcnt lgkmcnt(0)
    s_barrier
    v_mfma_f32_16x16x32_bf16 v[128:131], a[48:51], v[232:235], v[128:131]
    ds_read_b64_tr_b16 a[128:129], v14 offset:16384
    ds_read_b64_tr_b16 a[130:131], v14 offset:17408
    v_mfma_f32_16x16x32_bf16 v[132:135], a[48:51], v[248:251], v[132:135]
    ds_read_b64_tr_b16 a[132:133], v15 offset:16384
    ds_read_b64_tr_b16 a[134:135], v15 offset:17408
    v_mfma_f32_16x16x32_bf16 v[136:139], a[52:55], v[232:235], v[136:139]
    ds_read_b64_tr_b16 a[136:137], v16 offset:16384
    ds_read_b64_tr_b16 a[138:139], v16 offset:17408
    buffer_load_dwordx4 v6, s[4:7], s57 offen offset:2048  lds
    v_mfma_f32_16x16x32_bf16 v[140:143], a[52:55], v[248:251], v[140:143]
    ds_read_b64_tr_b16 a[140:141], v17 offset:16384
    v_mfma_f32_16x16x32_bf16 v[128:131], a[56:59], v[236:239], v[128:131]
    ds_read_b64_tr_b16 a[142:143], v17 offset:17408
    ds_read_b64_tr_b16 a[144:145], v18 offset:16384
    v_mfma_f32_16x16x32_bf16 v[132:135], a[56:59], v[252:255], v[132:135]
    ds_read_b64_tr_b16 a[146:147], v18 offset:17408
    ds_read_b64_tr_b16 a[148:149], v19 offset:16384
    v_mfma_f32_16x16x32_bf16 v[136:139], a[60:63], v[236:239], v[136:139]
    ds_read_b64_tr_b16 a[150:151], v19 offset:17408
    ds_read_b64_tr_b16 a[152:153], v20 offset:16384
    buffer_load_dwordx4 v7, s[4:7], s57 offen offset:3072  lds
    s_add_u32 s57, s57, 128
    s_and_b32 s57, s57, 1023
    v_mfma_f32_16x16x32_bf16 v[140:143], a[60:63], v[252:255], v[140:143]
    ds_read_b64_tr_b16 a[154:155], v20 offset:17408
    s_waitcnt lgkmcnt(6)
    v_mfma_f32_16x16x32_bf16 v[60:63], a[128:131], a[20:23], v[60:63]
    ds_read_b64_tr_b16 a[156:157], v14 offset:24576
    v_mfma_f32_16x16x32_bf16 v[56:59], a[128:131], a[16:19], v[56:59]
    ds_read_b64_tr_b16 a[158:159], v14 offset:25600
    s_add_u32 m0, s59, 0
    s_nop 0
    buffer_load_dwordx4 v4, s[4:7], s57 offen offset:0  lds
    v_mfma_f32_16x16x32_bf16 v[68:71], a[132:135], a[20:23], v[68:71]
    ds_read_b64_tr_b16 a[160:161], v15 offset:24576
    v_mfma_f32_16x16x32_bf16 v[64:67], a[132:135], a[16:19], v[64:67]
    ds_read_b64_tr_b16 a[162:163], v15 offset:25600
    v_mfma_f32_16x16x32_bf16 v[76:79], a[136:139], a[20:23], v[76:79]
    ds_read_b64_tr_b16 a[164:165], v16 offset:24576
    v_mfma_f32_16x16x32_bf16 v[72:75], a[136:139], a[16:19], v[72:75]
    ds_read_b64_tr_b16 a[166:167], v16 offset:25600
    buffer_load_dwordx4 v5, s[4:7], s57 offen offset:1024  lds
    v_mfma_f32_16x16x32_bf16 v[84:87], a[140:143], a[20:23], v[84:87]
    ds_read_b64_tr_b16 a[168:169], v17 offset:24576
    v_mfma_f32_16x16x32_bf16 v[80:83], a[140:143], a[16:19], v[80:83]
    ds_read_b64_tr_b16 a[170:171], v17 offset:25600
    s_waitcnt lgkmcnt(8)
    v_mfma_f32_16x16x32_bf16 v[92:95], a[144:147], a[20:23], v[92:95]
    ds_read_b64_tr_b16 a[172:173], v18 offset:24576
    buffer_load_dwordx4 v6, s[4:7], s57 offen offset:2048  lds
    v_mfma_f32_16x16x32_bf16 v[88:91], a[144:147], a[16:19], v[88:91]
    ds_read_b64_tr_b16 a[174:175], v18 offset:25600
    v_mfma_f32_16x16x32_bf16 v[100:103], a[148:151], a[20:23], v[100:103]
    ds_read_b64_tr_b16 a[176:177], v19 offset:24576
    v_mfma_f32_16x16x32_bf16 v[96:99], a[148:151], a[16:19], v[96:99]
    ds_read_b64_tr_b16 a[178:179], v19 offset:25600
    v_mfma_f32_16x16x32_bf16 v[108:111], a[152:155], a[20:23], v[108:111]
    ds_read_b64_tr_b16 a[180:181], v20 offset:24576
    buffer_load_dwordx4 v7, s[4:7], s57 offen offset:3072  lds
    s_add_u32 s57, s57, 128
    s_and_b32 s57, s57, 1023
    v_mfma_f32_16x16x32_bf16 v[104:107], a[152:155], a[16:19], v[104:107]
    ds_read_b64_tr_b16 a[182:183], v20 offset:25600
    buffer_load_dword v21, off, s[44:47], 0 sc1
    s_waitcnt vmcnt(13)
    s_waitcnt lgkmcnt(6)
    v_mfma_f32_16x16x32_bf16 v[60:63], a[156:159], a[28:31], v[60:63]
    ds_read_b128 a[64:67], v12 offset:4096
    v_mfma_f32_16x16x32_bf16 v[56:59], a[156:159], a[24:27], v[56:59]
    ds_read_b128 a[68:71], v12 offset:6144
    s_add_u32 m0, s60, 49152
    s_nop 0
    buffer_load_dwordx4 v8, s[12:15], s58 offen offset:0  lds
    v_mfma_f32_16x16x32_bf16 v[68:71], a[160:163], a[28:31], v[68:71]
    ds_read_b128 a[72:75], v13 offset:4096
    v_mfma_f32_16x16x32_bf16 v[64:67], a[160:163], a[24:27], v[64:67]
    ds_read_b128 a[76:79], v13 offset:6144
    v_mfma_f32_16x16x32_bf16 v[76:79], a[164:167], a[28:31], v[76:79]
    v_mfma_f32_16x16x32_bf16 v[72:75], a[164:167], a[24:27], v[72:75]
    buffer_load_dwordx4 v9, s[12:15], s58 offen offset:1024  lds
    v_mfma_f32_16x16x32_bf16 v[84:87], a[168:171], a[28:31], v[84:87]
    v_mfma_f32_16x16x32_bf16 v[80:83], a[168:171], a[24:27], v[80:83]
    s_waitcnt lgkmcnt(4)
    v_mfma_f32_16x16x32_bf16 v[92:95], a[172:175], a[28:31], v[92:95]
    buffer_load_dwordx4 v10, s[12:15], s58 offen offset:2048  lds
    v_mfma_f32_16x16x32_bf16 v[88:91], a[172:175], a[24:27], v[88:91]
    v_mfma_f32_16x16x32_bf16 v[100:103], a[176:179], a[28:31], v[100:103]
    v_mfma_f32_16x16x32_bf16 v[96:99], a[176:179], a[24:27], v[96:99]
    v_mfma_f32_16x16x32_bf16 v[108:111], a[180:183], a[28:31], v[108:111]
    buffer_load_dwordx4 v11, s[12:15], s58 offen offset:3072  lds
    s_add_u32 s58, s58, 229376
    s_cmp_eq_u32 s58, 1835008
    s_cselect_b32 s58, 0, s58
    v_mfma_f32_16x16x32_bf16 v[104:107], a[180:183], a[24:27], v[104:107]
    s_waitcnt lgkmcnt(0)
    s_waitcnt vmcnt(9)
    v_mfma_f32_16x16x32_bf16 v[144:147], a[64:67], v[224:227], 0
    ds_read_b128 a[80:83], v12 offset:8192
    v_mfma_f32_16x16x32_bf16 v[148:151], a[64:67], v[240:243], 0
    ds_read_b128 a[84:87], v12 offset:10240
    v_mfma_f32_16x16x32_bf16 v[152:155], a[68:71], v[224:227], 0
    ds_read_b128 a[88:91], v13 offset:8192
    s_add_u32 m0, s59, 4096
    s_nop 0
    buffer_load_dwordx4 v4, s[4:7], s57 offen offset:0  lds
    v_mfma_f32_16x16x32_bf16 v[156:159], a[68:71], v[240:243], 0
    ds_read_b128 a[92:95], v13 offset:10240
    v_mfma_f32_16x16x32_bf16 v[144:147], a[72:75], v[228:231], v[144:147]
    v_mfma_f32_16x16x32_bf16 v[148:151], a[72:75], v[244:247], v[148:151]
    v_mfma_f32_16x16x32_bf16 v[152:155], a[76:79], v[228:231], v[152:155]
    buffer_load_dwordx4 v5, s[4:7], s57 offen offset:1024  lds
    v_mfma_f32_16x16x32_bf16 v[156:159], a[76:79], v[244:247], v[156:159]
    s_waitcnt lgkmcnt(0)
    s_barrier
    v_mfma_f32_16x16x32_bf16 v[144:147], a[80:83], v[232:235], v[144:147]
    ds_read_b64_tr_b16 a[128:129], v14 offset:32768
    ds_read_b64_tr_b16 a[130:131], v14 offset:33792
    v_mfma_f32_16x16x32_bf16 v[148:151], a[80:83], v[248:251], v[148:151]
    ds_read_b64_tr_b16 a[132:133], v15 offset:32768
    ds_read_b64_tr_b16 a[134:135], v15 offset:33792
    v_mfma_f32_16x16x32_bf16 v[152:155], a[84:87], v[232:235], v[152:155]
    ds_read_b64_tr_b16 a[136:137], v16 offset:32768
    ds_read_b64_tr_b16 a[138:139], v16 offset:33792
    buffer_load_dwordx4 v6, s[4:7], s57 offen offset:2048  lds
    v_mfma_f32_16x16x32_bf16 v[156:159], a[84:87], v[248:251], v[156:159]
    ds_read_b64_tr_b16 a[140:141], v17 offset:32768
    v_mfma_f32_16x16x32_bf16 v[144:147], a[88:91], v[236:239], v[144:147]
    ds_read_b64_tr_b16 a[142:143], v17 offset:33792
    ds_read_b64_tr_b16 a[144:145], v18 offset:32768
    v_mfma_f32_16x16x32_bf16 v[148:151], a[88:91], v[252:255], v[148:151]
    ds_read_b64_tr_b16 a[146:147], v18 offset:33792
    ds_read_b64_tr_b16 a[148:149], v19 offset:32768
    v_mfma_f32_16x16x32_bf16 v[152:155], a[92:95], v[236:239], v[152:155]
    ds_read_b64_tr_b16 a[150:151], v19 offset:33792
    ds_read_b64_tr_b16 a[152:153], v20 offset:32768
    buffer_load_dwordx4 v7, s[4:7], s57 offen offset:3072  lds
    s_add_u32 s57, s57, 128
    s_and_b32 s57, s57, 1023
    v_mfma_f32_16x16x32_bf16 v[156:159], a[92:95], v[252:255], v[156:159]
    ds_read_b64_tr_b16 a[154:155], v20 offset:33792
    s_waitcnt lgkmcnt(6)
    v_mfma_f32_16x16x32_bf16 v[60:63], a[128:131], a[36:39], v[60:63]
    ds_read_b64_tr_b16 a[156:157], v14 offset:40960
    v_mfma_f32_16x16x32_bf16 v[56:59], a[128:131], a[32:35], v[56:59]
    ds_read_b64_tr_b16 a[158:159], v14 offset:41984
    s_add_u32 m0, s60, 65536
    s_nop 0
    buffer_load_dwordx4 v8, s[12:15], s58 offen offset:0  lds
    v_mfma_f32_16x16x32_bf16 v[68:71], a[132:135], a[36:39], v[68:71]
    ds_read_b64_tr_b16 a[160:161], v15 offset:40960
    v_mfma_f32_16x16x32_bf16 v[64:67], a[132:135], a[32:35], v[64:67]
    ds_read_b64_tr_b16 a[162:163], v15 offset:41984
    v_mfma_f32_16x16x32_bf16 v[76:79], a[136:139], a[36:39], v[76:79]
    ds_read_b64_tr_b16 a[164:165], v16 offset:40960
    v_mfma_f32_16x16x32_bf16 v[72:75], a[136:139], a[32:35], v[72:75]
    ds_read_b64_tr_b16 a[166:167], v16 offset:41984
    buffer_load_dwordx4 v9, s[12:15], s58 offen offset:1024  lds
    v_mfma_f32_16x16x32_bf16 v[84:87], a[140:143], a[36:39], v[84:87]
    ds_read_b64_tr_b16 a[168:169], v17 offset:40960
    v_mfma_f32_16x16x32_bf16 v[80:83], a[140:143], a[32:35], v[80:83]
    ds_read_b64_tr_b16 a[170:171], v17 offset:41984
    s_waitcnt lgkmcnt(8)
    v_mfma_f32_16x16x32_bf16 v[92:95], a[144:147], a[36:39], v[92:95]
    ds_read_b64_tr_b16 a[172:173], v18 offset:40960
    buffer_load_dwordx4 v10, s[12:15], s58 offen offset:2048  lds
    v_mfma_f32_16x16x32_bf16 v[88:91], a[144:147], a[32:35], v[88:91]
    ds_read_b64_tr_b16 a[174:175], v18 offset:41984
    v_mfma_f32_16x16x32_bf16 v[100:103], a[148:151], a[36:39], v[100:103]
    ds_read_b64_tr_b16 a[176:177], v19 offset:40960
    v_mfma_f32_16x16x32_bf16 v[96:99], a[148:151], a[32:35], v[96:99]
    ds_read_b64_tr_b16 a[178:179], v19 offset:41984
    v_mfma_f32_16x16x32_bf16 v[108:111], a[152:155], a[36:39], v[108:111]
    ds_read_b64_tr_b16 a[180:181], v20 offset:40960
    buffer_load_dwordx4 v11, s[12:15], s58 offen offset:3072  lds
    s_add_u32 s58, s58, 229376
    s_cmp_eq_u32 s58, 1835008
    s_cselect_b32 s58, 0, s58
    v_mfma_f32_16x16x32_bf16 v[104:107], a[152:155], a[32:35], v[104:107]
    ds_read_b64_tr_b16 a[182:183], v20 offset:41984
    s_waitcnt vmcnt(12)
    v_cmp_eq_u32 vcc, 0, v21
    s_nop 1
    s_cbranch_vccnz L_poll_6
L_polled_7:
    v_readfirstlane_b32 s101, v21
    s_waitcnt lgkmcnt(6)
    v_mfma_f32_16x16x32_bf16 v[60:63], a[156:159], a[44:47], v[60:63]
    ds_read_b128 a[96:99], v12 offset:0
    v_mfma_f32_16x16x32_bf16 v[56:59], a[156:159], a[40:43], v[56:59]
    ds_read_b128 a[100:103], v12 offset:2048
    s_add_u32 m0, s60, 81920
    s_nop 0
    buffer_load_dwordx4 v8, s[12:15], s58 offen offset:0  lds
    v_mfma_f32_16x16x32_bf16 v[68:71], a[160:163], a[44:47], v[68:71]
    ds_read_b128 a[104:107], v13 offset:0
    v_mfma_f32_16x16x32_bf16 v[64:67], a[160:163], a[40:43], v[64:67]
    ds_read_b128 a[108:111], v13 offset:2048
    v_mfma_f32_16x16x32_bf16 v[76:79], a[164:167], a[44:47], v[76:79]
    v_mfma_f32_16x16x32_bf16 v[72:75], a[164:167], a[40:43], v[72:75]
    buffer_load_dwordx4 v9, s[12:15], s58 offen offset:1024  lds
    v_mfma_f32_16x16x32_bf16 v[84:87], a[168:171], a[44:47], v[84:87]
    v_mfma_f32_16x16x32_bf16 v[80:83], a[168:171], a[40:43], v[80:83]
    s_waitcnt lgkmcnt(4)
    v_mfma_f32_16x16x32_bf16 v[92:95], a[172:175], a[44:47], v[92:95]
    buffer_load_dwordx4 v10, s[12:15], s58 offen offset:2048  lds
    v_mfma_f32_16x16x32_bf16 v[88:91], a[172:175], a[40:43], v[88:91]
    v_mfma_f32_16x16x32_bf16 v[100:103], a[176:179], a[44:47], v[100:103]
    v_mfma_f32_16x16x32_bf16 v[96:99], a[176:179], a[40:43], v[96:99]
    v_mfma_f32_16x16x32_bf16 v[108:111], a[180:183], a[44:47], v[108:111]
    buffer_load_dwordx4 v11, s[12:15], s58 offen offset:3072  lds
    s_add_u32 s58, s58, 229376
    s_cmp_eq_u32 s58, 1835008
    s_cselect_b32 s58, 0, s58
    v_mfma_f32_16x16x32_bf16 v[104:107], a[180:183], a[40:43], v[104:107]
    s_waitcnt lgkmcnt(0)
    s_waitcnt vmcnt(8)
    v_mfma_f32_16x16x32_bf16 v[160:163], a[96:99], v[224:227], 0
    ds_read_b128 a[112:115], v12 offset:4096
    v_mfma_f32_16x16x32_bf16 v[164:167], a[96:99], v[240:243], 0
    ds_read_b128 a[116:119], v12 offset:6144
    v_mfma_f32_16x16x32_bf16 v[168:171], a[100:103], v[224:227], 0
    ds_read_b128 a[120:123], v13 offset:4096
    s_add_u32 m0, s60, 0
    s_nop 0
    buffer_load_dwordx4 v8, s[12:15], s58 offen offset:0  lds
    v_mfma_f32_16x16x32_bf16 v[172:175], a[100:103], v[240:243], 0
    ds_read_b128 a[124:127], v13 offset:6144
    v_mfma_f32_16x16x32_bf16 v[160:163], a[104:107], v[228:231], v[160:163]
    v_mfma_f32_16x16x32_bf16 v[164:167], a[104:107], v[244:247], v[164:167]
    v_mfma_f32_16x16x32_bf16 v[168:171], a[108:111], v[228:231], v[168:171]
    buffer_load_dwordx4 v9, s[12:15], s58 offen offset:1024  lds
    v_mfma_f32_16x16x32_bf16 v[172:175], a[108:111], v[244:247], v[172:175]
    s_waitcnt lgkmcnt(0)
    s_barrier
    v_mfma_f32_16x16x32_bf16 v[160:163], a[112:115], v[232:235], v[160:163]
    ds_read_b64_tr_b16 a[128:129], v14 offset:49152
    ds_read_b64_tr_b16 a[130:131], v14 offset:50176
    v_mfma_f32_16x16x32_bf16 v[164:167], a[112:115], v[248:251], v[164:167]
    ds_read_b64_tr_b16 a[132:133], v15 offset:49152
    ds_read_b64_tr_b16 a[134:135], v15 offset:50176
    v_mfma_f32_16x16x32_bf16 v[168:171], a[116:119], v[232:235], v[168:171]
    ds_read_b64_tr_b16 a[136:137], v16 offset:49152
    ds_read_b64_tr_b16 a[138:139], v16 offset:50176
    buffer_load_dwordx4 v10, s[12:15], s58 offen offset:2048  lds
    v_mfma_f32_16x16x32_bf16 v[172:175], a[116:119], v[248:251], v[172:175]
    ds_read_b64_tr_b16 a[140:141], v17 offset:49152
    v_mfma_f32_16x16x32_bf16 v[160:163], a[120:123], v[236:239], v[160:163]
    ds_read_b64_tr_b16 a[142:143], v17 offset:50176
    ds_read_b64_tr_b16 a[144:145], v18 offset:49152
    v_mfma_f32_16x16x32_bf16 v[164:167], a[120:123], v[252:255], v[164:167]
    ds_read_b64_tr_b16 a[146:147], v18 offset:50176
    ds_read_b64_tr_b16 a[148:149], v19 offset:49152
    v_mfma_f32_16x16x32_bf16 v[168:171], a[124:127], v[236:239], v[168:171]
    ds_read_b64_tr_b16 a[150:151], v19 offset:50176
    ds_read_b64_tr_b16 a[152:153], v20 offset:49152
    buffer_load_dwordx4 v11, s[12:15], s58 offen offset:3072  lds
    s_add_u32 s58, s58, 229376
    s_cmp_eq_u32 s58, 1835008
    s_cselect_b32 s58, 0, s58
    v_mfma_f32_16x16x32_bf16 v[172:175], a[124:127], v[252:255], v[172:175]
    ds_read_b64_tr_b16 a[154:155], v20 offset:50176
    buffer_store_dwordx4 v[46:49], v3, s[8:11], s75 offen sc1
    buffer_store_dwordx4 v[50:53], v3, s[8:11], s76 offen sc1
    s_and_b32 s72, s52, 3
    s_cmp_eq_u32 s56, 0
    s_cselect_b32 s66, 1.0, -1.0
    s_cselect_b32 s68, 1.0, 0
    s_cselect_b32 s70, 0, -1.0
    s_lshl_b32 s72, s72, 30
    s_and_b32 s72, s72, 0x80000000
    s_xor_b32 s68, s68, s72
    s_xor_b32 s70, s70, s72
    s_mov_b32 s67, s66
    s_mov_b32 s69, s68
    s_mov_b32 s71, s70
    v_pk_fma_f32 v[112:113], v[144:145], s[66:67], v[112:113]
    v_pk_fma_f32 v[114:115], v[146:147], s[66:67], v[114:115]
    v_pk_fma_f32 v[116:117], v[148:149], s[66:67], v[116:117]
    v_pk_fma_f32 v[118:119], v[150:151], s[66:67], v[118:119]
    v_pk_fma_f32 v[120:121], v[152:153], s[66:67], v[120:121]
    v_pk_fma_f32 v[122:123], v[154:155], s[66:67], v[122:123]
    v_pk_fma_f32 v[124:125], v[156:157], s[66:67], v[124:125]
    v_pk_fma_f32 v[126:127], v[158:159], s[66:67], v[126:127]
    v_pk_fma_f32 v[128:129], v[160:161], s[66:67], v[128:129]
    v_pk_fma_f32 v[130:131], v[162:163], s[66:67], v[130:131]
    v_pk_fma_f32 v[132:133], v[164:165], s[66:67], v[132:133]
    v_pk_fma_f32 v[134:135], v[166:167], s[66:67], v[134:135]
    v_pk_fma_f32 v[136:137], v[168:169], s[66:67], v[136:137]
    v_pk_fma_f32 v[138:139], v[170:171], s[66:67], v[138:139]
    v_pk_fma_f32 v[140:141], v[172:173], s[66:67], v[140:141]
    v_pk_fma_f32 v[142:143], v[174:175], s[66:67], v[142:143]
    v_pk_fma_f32 v[112:113], v[128:129], s[68:69], v[112:113]
    v_pk_fma_f32 v[116:117], v[132:133], s[68:69], v[116:117]
    v_pk_fma_f32 v[112:113], v[132:133], s[70:71], v[112:113] neg_lo:[1,0,0] neg_hi:[1,0,0]
    v_pk_fma_f32 v[116:117], v[128:129], s[70:71], v[116:117]
    v_pk_fma_f32 v[114:115], v[130:131], s[68:69], v[114:115]
    v_pk_fma_f32 v[118:119], v[134:135], s[68:69], v[118:119]
    v_pk_fma_f32 v[114:115], v[134:135], s[70:71], v[114:115] neg_lo:[1,0,0] neg_hi:[1,0,0]
    v_pk_fma_f32 v[118:119], v[130:131], s[70:71], v[118:119]
    v_pk_fma_f32 v[120:121], v[136:137], s[68:69], v[120:121]
    v_pk_fma_f32 v[124:125], v[140:141], s[68:69], v[124:125]
    v_pk_fma_f32 v[120:121], v[140:141], s[70:71], v[120:121] neg_lo:[1,0,0] neg_hi:[1,0,0]
    v_pk_fma_f32 v[124:125], v[136:137], s[70:71], v[124:125]
    v_pk_fma_f32 v[122:123], v[138:139], s[68:69], v[122:123]
    v_pk_fma_f32 v[126:127], v[142:143], s[68:69], v[126:127]
    v_pk_fma_f32 v[122:123], v[142:143], s[70:71], v[122:123] neg_lo:[1,0,0] neg_hi:[1,0,0]
    v_pk_fma_f32 v[126:127], v[138:139], s[70:71], v[126:127]
    v_cvt_pk_bf16_f32 v144, v112, v113
    v_cvt_pk_bf16_f32 v148, v116, v117
    v_cvt_pk_bf16_f32 v152, -v112, -v113
    v_cvt_pk_bf16_f32 v145, v114, v115
    v_cvt_pk_bf16_f32 v149, v118, v119
    v_cvt_pk_bf16_f32 v153, -v114, -v115
    v_cvt_pk_bf16_f32 v146, v120, v121
    v_cvt_pk_bf16_f32 v150, v124, v125
    v_cvt_pk_bf16_f32 v154, -v120, -v121
    v_cvt_pk_bf16_f32 v147, v122, v123
    v_cvt_pk_bf16_f32 v151, v126, v127
    v_cvt_pk_bf16_f32 v155, -v122, -v123
    v_mfma_f32_16x16x32_bf16 v[160:163], v[144:147], v[208:211], 0
    v_mfma_f32_16x16x32_bf16 v[164:167], v[148:151], v[208:211], 0
    v_mfma_f32_16x16x32_bf16 v[168:171], v[144:147], v[212:215], 0
    v_mfma_f32_16x16x32_bf16 v[172:175], v[148:151], v[212:215], 0
    v_mfma_f32_16x16x32_bf16 v[160:163], v[148:151], v[216:219], v[160:163]
    v_mfma_f32_16x16x32_bf16 v[164:167], v[152:155], v[216:219], v[164:167]
    v_mfma_f32_16x16x32_bf16 v[168:171], v[148:151], v[220:223], v[168:171]
    v_mfma_f32_16x16x32_bf16 v[172:175], v[152:155], v[220:223], v[172:175]
    v_lshlrev_b32 v22, 4, v2
    v_lshl_add_u32 v22, v1, 16, v22
    s_lshl_b32 s66, s55, 5
    s_add_u32 s66, s66, s54
    s_lshl_b32 s66, s66, 6
    s_lshl_b32 s67, s52, 12
    s_add_u32 s66, s66, s67
    s_add_u32 s66, s66, 10485760
    s_add_u32 s67, s66, 1048576
    v_cvt_pk_bf16_f32 v112, v160, v161
    v_cvt_pk_bf16_f32 v113, v162, v163
    v_cvt_pk_bf16_f32 v114, v164, v165
    v_cvt_pk_bf16_f32 v115, v166, v167
    buffer_store_dwordx4 v[112:115], v22, s[8:11], s66 offen sc1
    v_cvt_pk_bf16_f32 v116, v168, v169
    v_cvt_pk_bf16_f32 v117, v170, v171
    v_cvt_pk_bf16_f32 v118, v172, v173
    v_cvt_pk_bf16_f32 v119, v174, v175
    buffer_store_dwordx4 v[116:119], v22, s[8:11], s67 offen sc1
    s_waitcnt lgkmcnt(6)
    v_mfma_f32_16x16x32_bf16 v[60:63], a[128:131], a[52:55], v[60:63]
    ds_read_b64_tr_b16 a[156:157], v14 offset:57344
    v_mfma_f32_16x16x32_bf16 v[56:59], a[128:131], a[48:51], v[56:59]
    ds_read_b64_tr_b16 a[158:159], v14 offset:58368
    v_mfma_f32_16x16x32_bf16 v[68:71], a[132:135], a[52:55], v[68:71]
    ds_read_b64_tr_b16 a[160:161], v15 offset:57344
    v_mfma_f32_16x16x32_bf16 v[64:67], a[132:135], a[48:51], v[64:67]
    ds_read_b64_tr_b16 a[162:163], v15 offset:58368
    v_mfma_f32_16x16x32_bf16 v[76:79], a[136:139], a[52:55], v[76:79]
    ds_read_b64_tr_b16 a[164:165], v16 offset:57344
    v_mfma_f32_16x16x32_bf16 v[72:75], a[136:139], a[48:51], v[72:75]
    ds_read_b64_tr_b16 a[166:167], v16 offset:58368
    v_mfma_f32_16x16x32_bf16 v[84:87], a[140:143], a[52:55], v[84:87]
    ds_read_b64_tr_b16 a[168:169], v17 offset:57344
    v_mfma_f32_16x16x32_bf16 v[80:83], a[140:143], a[48:51], v[80:83]
    ds_read_b64_tr_b16 a[170:171], v17 offset:58368
    s_waitcnt lgkmcnt(8)
    v_mfma_f32_16x16x32_bf16 v[92:95], a[144:147], a[52:55], v[92:95]
    ds_read_b64_tr_b16 a[172:173], v18 offset:57344
    v_mfma_f32_16x16x32_bf16 v[88:91], a[144:147], a[48:51], v[88:91]
    ds_read_b64_tr_b16 a[174:175], v18 offset:58368
    v_mfma_f32_16x16x32_bf16 v[100:103], a[148:151], a[52:55], v[100:103]
    ds_read_b64_tr_b16 a[176:177], v19 offset:57344
    v_mfma_f32_16x16x32_bf16 v[96:99], a[148:151], a[48:51], v[96:99]
    ds_read_b64_tr_b16 a[178:179], v19 offset:58368
    v_mfma_f32_16x16x32_bf16 v[108:111], a[152:155], a[52:55], v[108:111]
    ds_read_b64_tr_b16 a[180:181], v20 offset:57344
    v_mfma_f32_16x16x32_bf16 v[104:107], a[152:155], a[48:51], v[104:107]
    ds_read_b64_tr_b16 a[182:183], v20 offset:58368
    s_waitcnt vmcnt(12)
    s_barrier
    v_add_u32 v14, 0x10000, v14
    v_add_u32 v15, 0x10000, v15
    v_add_u32 v16, 0x10000, v16
    v_add_u32 v17, 0x10000, v17
    v_add_u32 v18, 0x10000, v18
    v_add_u32 v19, 0x10000, v19
    v_add_u32 v20, 0x10000, v20
    s_waitcnt lgkmcnt(6)
    v_mfma_f32_16x16x32_bf16 v[60:63], a[156:159], a[60:63], v[60:63]
    ds_read_b64_tr_b16 a[128:129], v14 offset:0
    v_mfma_f32_16x16x32_bf16 v[56:59], a[156:159], a[56:59], v[56:59]
    ds_read_b64_tr_b16 a[130:131], v14 offset:1024
    v_mfma_f32_16x16x32_bf16 v[68:71], a[160:163], a[60:63], v[68:71]
    ds_read_b64_tr_b16 a[132:133], v15 offset:0
    v_mfma_f32_16x16x32_bf16 v[64:67], a[160:163], a[56:59], v[64:67]
    ds_read_b64_tr_b16 a[134:135], v15 offset:1024
    v_mfma_f32_16x16x32_bf16 v[76:79], a[164:167], a[60:63], v[76:79]
    ds_read_b64_tr_b16 a[136:137], v16 offset:0
    v_mfma_f32_16x16x32_bf16 v[72:75], a[164:167], a[56:59], v[72:75]
    ds_read_b64_tr_b16 a[138:139], v16 offset:1024
    v_mfma_f32_16x16x32_bf16 v[84:87], a[168:171], a[60:63], v[84:87]
    ds_read_b64_tr_b16 a[140:141], v17 offset:0
    v_mfma_f32_16x16x32_bf16 v[80:83], a[168:171], a[56:59], v[80:83]
    ds_read_b64_tr_b16 a[142:143], v17 offset:1024
    s_waitcnt lgkmcnt(8)
    v_mfma_f32_16x16x32_bf16 v[92:95], a[172:175], a[60:63], v[92:95]
    ds_read_b64_tr_b16 a[144:145], v18 offset:0
    v_mfma_f32_16x16x32_bf16 v[88:91], a[172:175], a[56:59], v[88:91]
    ds_read_b64_tr_b16 a[146:147], v18 offset:1024
    v_mfma_f32_16x16x32_bf16 v[100:103], a[176:179], a[60:63], v[100:103]
    ds_read_b64_tr_b16 a[148:149], v19 offset:0
    v_mfma_f32_16x16x32_bf16 v[96:99], a[176:179], a[56:59], v[96:99]
    ds_read_b64_tr_b16 a[150:151], v19 offset:1024
    v_mfma_f32_16x16x32_bf16 v[108:111], a[180:183], a[60:63], v[108:111]
    ds_read_b64_tr_b16 a[152:153], v20 offset:0
    v_mfma_f32_16x16x32_bf16 v[104:107], a[180:183], a[56:59], v[104:107]
    ds_read_b64_tr_b16 a[154:155], v20 offset:1024
    s_waitcnt lgkmcnt(6)
    v_mfma_f32_16x16x32_bf16 v[60:63], a[128:131], a[68:71], v[60:63]
    ds_read_b64_tr_b16 a[156:157], v14 offset:8192
    v_mfma_f32_16x16x32_bf16 v[56:59], a[128:131], a[64:67], v[56:59]
    ds_read_b64_tr_b16 a[158:159], v14 offset:9216
    s_add_u32 m0, s60, 16384
    s_nop 0
    buffer_load_dwordx4 v8, s[12:15], s58 offen offset:0  lds
    v_mfma_f32_16x16x32_bf16 v[68:71], a[132:135], a[68:71], v[68:71]
    ds_read_b64_tr_b16 a[160:161], v15 offset:8192
    v_mfma_f32_16x16x32_bf16 v[64:67], a[132:135], a[64:67], v[64:67]
    ds_read_b64_tr_b16 a[162:163], v15 offset:9216
    v_mfma_f32_16x16x32_bf16 v[76:79], a[136:139], a[68:71], v[76:79]
    ds_read_b64_tr_b16 a[164:165], v16 offset:8192
    v_mfma_f32_16x16x32_bf16 v[72:75], a[136:139], a[64:67], v[72:75]
    ds_read_b64_tr_b16 a[166:167], v16 offset:9216
    buffer_load_dwordx4 v9, s[12:15], s58 offen offset:1024  lds
    v_mfma_f32_16x16x32_bf16 v[84:87], a[140:143], a[68:71], v[84:87]
    ds_read_b64_tr_b16 a[168:169], v17 offset:8192
    v_mfma_f32_16x16x32_bf16 v[80:83], a[140:143], a[64:67], v[80:83]
    ds_read_b64_tr_b16 a[170:171], v17 offset:9216
    s_waitcnt lgkmcnt(8)
    v_mfma_f32_16x16x32_bf16 v[92:95], a[144:147], a[68:71], v[92:95]
    ds_read_b64_tr_b16 a[172:173], v18 offset:8192
    buffer_load_dwordx4 v10, s[12:15], s58 offen offset:2048  lds
    v_mfma_f32_16x16x32_bf16 v[88:91], a[144:147], a[64:67], v[88:91]
    ds_read_b64_tr_b16 a[174:175], v18 offset:9216
    v_mfma_f32_16x16x32_bf16 v[100:103], a[148:151], a[68:71], v[100:103]
    ds_read_b64_tr_b16 a[176:177], v19 offset:8192
    v_mfma_f32_16x16x32_bf16 v[96:99], a[148:151], a[64:67], v[96:99]
    ds_read_b64_tr_b16 a[178:179], v19 offset:9216
    v_mfma_f32_16x16x32_bf16 v[108:111], a[152:155], a[68:71], v[108:111]
    ds_read_b64_tr_b16 a[180:181], v20 offset:8192
    buffer_load_dwordx4 v11, s[12:15], s58 offen offset:3072  lds
    s_add_u32 s58, s58, 229376
    s_cmp_eq_u32 s58, 1835008
    s_cselect_b32 s58, 0, s58
    v_mfma_f32_16x16x32_bf16 v[104:107], a[152:155], a[64:67], v[104:107]
    ds_read_b64_tr_b16 a[182:183], v20 offset:9216
    s_waitcnt vmcnt(12)
    s_barrier
    s_waitcnt lgkmcnt(6)
    v_mfma_f32_16x16x32_bf16 v[60:63], a[156:159], a[76:79], v[60:63]
    ds_read_b64_tr_b16 a[128:129], v14 offset:16384
    v_mfma_f32_16x16x32_bf16 v[56:59], a[156:159], a[72:75], v[56:59]
    ds_read_b64_tr_b16 a[130:131], v14 offset:17408
    v_mfma_f32_16x16x32_bf16 v[68:71], a[160:163], a[76:79], v[68:71]
    ds_read_b64_tr_b16 a[132:133], v15 offset:16384
    v_mfma_f32_16x16x32_bf16 v[64:67], a[160:163], a[72:75], v[64:67]
    ds_read_b64_tr_b16 a[134:135], v15 offset:17408
    v_mfma_f32_16x16x32_bf16 v[76:79], a[164:167], a[76:79], v[76:79]
    ds_read_b64_tr_b16 a[136:137], v16 offset:16384
    v_mfma_f32_16x16x32_bf16 v[72:75], a[164:167], a[72:75], v[72:75]
    ds_read_b64_tr_b16 a[138:139], v16 offset:17408
    v_mfma_f32_16x16x32_bf16 v[84:87], a[168:171], a[76:79], v[84:87]
    ds_read_b64_tr_b16 a[140:141], v17 offset:16384
    v_mfma_f32_16x16x32_bf16 v[80:83], a[168:171], a[72:75], v[80:83]
    ds_read_b64_tr_b16 a[142:143], v17 offset:17408
    s_waitcnt lgkmcnt(8)
    v_mfma_f32_16x16x32_bf16 v[92:95], a[172:175], a[76:79], v[92:95]
    ds_read_b64_tr_b16 a[144:145], v18 offset:16384
    v_mfma_f32_16x16x32_bf16 v[88:91], a[172:175], a[72:75], v[88:91]
    ds_read_b64_tr_b16 a[146:147], v18 offset:17408
    v_mfma_f32_16x16x32_bf16 v[100:103], a[176:179], a[76:79], v[100:103]
    ds_read_b64_tr_b16 a[148:149], v19 offset:16384
    v_mfma_f32_16x16x32_bf16 v[96:99], a[176:179], a[72:75], v[96:99]
    ds_read_b64_tr_b16 a[150:151], v19 offset:17408
    v_mfma_f32_16x16x32_bf16 v[108:111], a[180:183], a[76:79], v[108:111]
    ds_read_b64_tr_b16 a[152:153], v20 offset:16384
    v_mfma_f32_16x16x32_bf16 v[104:107], a[180:183], a[72:75], v[104:107]
    ds_read_b64_tr_b16 a[154:155], v20 offset:17408
    s_waitcnt lgkmcnt(6)
    v_mfma_f32_16x16x32_bf16 v[60:63], a[128:131], a[84:87], v[60:63]
    ds_read_b64_tr_b16 a[156:157], v14 offset:24576
    v_mfma_f32_16x16x32_bf16 v[56:59], a[128:131], a[80:83], v[56:59]
    ds_read_b64_tr_b16 a[158:159], v14 offset:25600
    buffer_load_short_d16_hi v40, v28, s[16:19], s24 offen
    v_mfma_f32_16x16x32_bf16 v[68:71], a[132:135], a[84:87], v[68:71]
    ds_read_b64_tr_b16 a[160:161], v15 offset:24576
    v_mfma_f32_16x16x32_bf16 v[64:67], a[132:135], a[80:83], v[64:67]
    ds_read_b64_tr_b16 a[162:163], v15 offset:25600
    v_mfma_f32_16x16x32_bf16 v[76:79], a[136:139], a[84:87], v[76:79]
    ds_read_b64_tr_b16 a[164:165], v16 offset:24576
    v_mfma_f32_16x16x32_bf16 v[72:75], a[136:139], a[80:83], v[72:75]
    ds_read_b64_tr_b16 a[166:167], v16 offset:25600
    buffer_load_short_d16_hi v48, v28, s[20:23], s24 offen
    s_add_u32 s24, s24, 32896
    v_mfma_f32_16x16x32_bf16 v[84:87], a[140:143], a[84:87], v[84:87]
    ds_read_b64_tr_b16 a[168:169], v17 offset:24576
    v_mfma_f32_16x16x32_bf16 v[80:83], a[140:143], a[80:83], v[80:83]
    ds_read_b64_tr_b16 a[170:171], v17 offset:25600
    s_waitcnt lgkmcnt(8)
    v_mfma_f32_16x16x32_bf16 v[92:95], a[144:147], a[84:87], v[92:95]
    ds_read_b64_tr_b16 a[172:173], v18 offset:24576
    buffer_load_short_d16_hi v41, v28, s[16:19], s24 offen
    v_mfma_f32_16x16x32_bf16 v[88:91], a[144:147], a[80:83], v[88:91]
    ds_read_b64_tr_b16 a[174:175], v18 offset:25600
    v_mfma_f32_16x16x32_bf16 v[100:103], a[148:151], a[84:87], v[100:103]
    ds_read_b64_tr_b16 a[176:177], v19 offset:24576
    v_mfma_f32_16x16x32_bf16 v[96:99], a[148:151], a[80:83], v[96:99]
    ds_read_b64_tr_b16 a[178:179], v19 offset:25600
    v_mfma_f32_16x16x32_bf16 v[108:111], a[152:155], a[84:87], v[108:111]
    ds_read_b64_tr_b16 a[180:181], v20 offset:24576
    buffer_load_short_d16_hi v49, v28, s[20:23], s24 offen
    s_add_u32 s24, s24, 32896
    v_mfma_f32_16x16x32_bf16 v[104:107], a[152:155], a[80:83], v[104:107]
    ds_read_b64_tr_b16 a[182:183], v20 offset:25600
    s_waitcnt vmcnt(8)
    s_barrier
    s_lshl_b32 s66, s2, 4
    s_add_u32 s66, s66, 17829888
    s_cmp_lg_u32 s48, 0
    s_cbranch_scc1 L_noarr_8
    s_mov_b32 s98, s101
    s_atomic_swap s98, s[8:9], s66 glc
L_noarr_8:
    s_lshl_b32 s66, s52, 8
    s_lshl_b32 s67, s51, 4
    s_add_u32 s66, s66, s67
    s_add_u32 s66, s66, 17825792
    s_cmp_lg_u32 s48, 0
    s_cbranch_scc1 L_noarr_9
    s_mov_b32 s3, s101
    s_atomic_swap s3, s[8:9], s66 glc
L_noarr_9:
    v_subrev_u32 v14, 0x10000, v14
    v_subrev_u32 v15, 0x10000, v15
    v_subrev_u32 v16, 0x10000, v16
    v_subrev_u32 v17, 0x10000, v17
    v_subrev_u32 v18, 0x10000, v18
    v_subrev_u32 v19, 0x10000, v19
    v_subrev_u32 v20, 0x10000, v20
    s_waitcnt lgkmcnt(6)
    v_mfma_f32_16x16x32_bf16 v[60:63], a[156:159], a[92:95], v[60:63]
    ds_read_b64_tr_b16 a[128:129], v14 offset:0
    v_mfma_f32_16x16x32_bf16 v[56:59], a[156:159], a[88:91], v[56:59]
    ds_read_b64_tr_b16 a[130:131], v14 offset:1024
    s_cmp_lg_u32 s25, 0
    s_cbranch_scc1 L_noabl_5
    buffer_load_short_d16_hi v136, v26, s[16:19], 0 offen offset:0
    buffer_load_short_d16_hi v137, v26, s[20:23], 0 offen offset:0
    buffer_load_short_d16_hi v138, v27, s[16:19], 0 offen offset:0
    buffer_load_short_d16_hi v139, v27, s[20:23], 0 offen offset:0
    buffer_load_short_d16_hi v140, v26, s[16:19], 0 offen offset:512
    buffer_load_short_d16_hi v141, v26, s[20:23], 0 offen offset:512
    buffer_load_short_d16_hi v142, v27, s[16:19], 0 offen offset:512
    buffer_load_short_d16_hi v143, v27, s[20:23], 0 offen offset:512
L_noabl_5:
    v_mfma_f32_16x16x32_bf16 v[68:71], a[160:163], a[92:95], v[68:71]
    ds_read_b64_tr_b16 a[132:133], v15 offset:0
    v_mfma_f32_16x16x32_bf16 v[64:67], a[160:163], a[88:91], v[64:67]
    ds_read_b64_tr_b16 a[134:135], v15 offset:1024
    v_mfma_f32_16x16x32_bf16 v[76:79], a[164:167], a[92:95], v[76:79]
    ds_read_b64_tr_b16 a[136:137], v16 offset:0
    v_mfma_f32_16x16x32_bf16 v[72:75], a[164:167], a[88:91], v[72:75]
    ds_read_b64_tr_b16 a[138:139], v16 offset:1024
    buffer_load_short_d16_hi v42, v28, s[16:19], s24 offen
    v_mfma_f32_16x16x32_bf16 v[84:87], a[168:171], a[92:95], v[84:87]
    ds_read_b64_tr_b16 a[140:141], v17 offset:0
    v_mfma_f32_16x16x32_bf16 v[80:83], a[168:171], a[88:91], v[80:83]
    ds_read_b64_tr_b16 a[142:143], v17 offset:1024
    s_waitcnt lgkmcnt(8)
    v_mfma_f32_16x16x32_bf16 v[92:95], a[172:175], a[92:95], v[92:95]
    ds_read_b64_tr_b16 a[144:145], v18 offset:0
    buffer_load_short_d16_hi v50, v28, s[20:23], s24 offen
    s_add_u32 s24, s24, 32896
    v_mfma_f32_16x16x32_bf16 v[88:91], a[172:175], a[88:91], v[88:91]
    ds_read_b64_tr_b16 a[146:147], v18 offset:1024
    v_mfma_f32_16x16x32_bf16 v[100:103], a[176:179], a[92:95], v[100:103]
    ds_read_b64_tr_b16 a[148:149], v19 offset:0
    v_mfma_f32_16x16x32_bf16 v[96:99], a[176:179], a[88:91], v[96:99]
    ds_read_b64_tr_b16 a[150:151], v19 offset:1024
    v_mfma_f32_16x16x32_bf16 v[108:111], a[180:183], a[92:95], v[108:111]
    ds_read_b64_tr_b16 a[152:153], v20 offset:0
    buffer_load_short_d16_hi v43, v28, s[16:19], s24 offen
    v_mfma_f32_16x16x32_bf16 v[104:107], a[180:183], a[88:91], v[104:107]
    ds_read_b64_tr_b16 a[154:155], v20 offset:1024
    s_waitcnt lgkmcnt(6)
    v_mfma_f32_16x16x32_bf16 v[60:63], a[128:131], a[100:103], v[60:63]
    ds_read_b64_tr_b16 a[156:157], v14 offset:8192
    v_mfma_f32_16x16x32_bf16 v[56:59], a[128:131], a[96:99], v[56:59]
    ds_read_b64_tr_b16 a[158:159], v14 offset:9216
    v_mfma_f32_16x16x32_bf16 v[68:71], a[132:135], a[100:103], v[68:71]
    ds_read_b64_tr_b16 a[160:161], v15 offset:8192
    buffer_load_short_d16_hi v51, v28, s[20:23], s24 offen
    s_add_u32 s24, s24, 427648
    v_mfma_f32_16x16x32_bf16 v[64:67], a[132:135], a[96:99], v[64:67]
    ds_read_b64_tr_b16 a[162:163], v15 offset:9216
    v_mfma_f32_16x16x32_bf16 v[76:79], a[136:139], a[100:103], v[76:79]
    ds_read_b64_tr_b16 a[164:165], v16 offset:8192
    v_mfma_f32_16x16x32_bf16 v[72:75], a[136:139], a[96:99], v[72:75]
    ds_read_b64_tr_b16 a[166:167], v16 offset:9216
    v_mfma_f32_16x16x32_bf16 v[84:87], a[140:143], a[100:103], v[84:87]
    ds_read_b64_tr_b16 a[168:169], v17 offset:8192
    v_mfma_f32_16x16x32_bf16 v[80:83], a[140:143], a[96:99], v[80:83]
    ds_read_b64_tr_b16 a[170:171], v17 offset:9216
    buffer_load_short_d16_hi v44, v28, s[16:19], s24 offen
    s_waitcnt lgkmcnt(8)
    v_mfma_f32_16x16x32_bf16 v[92:95], a[144:147], a[100:103], v[92:95]
    ds_read_b64_tr_b16 a[172:173], v18 offset:8192
    v_mfma_f32_16x16x32_bf16 v[88:91], a[144:147], a[96:99], v[88:91]
    ds_read_b64_tr_b16 a[174:175], v18 offset:9216
    v_mfma_f32_16x16x32_bf16 v[100:103], a[148:151], a[100:103], v[100:103]
    ds_read_b64_tr_b16 a[176:177], v19 offset:8192
    v_mfma_f32_16x16x32_bf16 v[96:99], a[148:151], a[96:99], v[96:99]
    ds_read_b64_tr_b16 a[178:179], v19 offset:9216
    buffer_load_short_d16_hi v52, v28, s[20:23], s24 offen
    s_add_u32 s24, s24, 32896
    v_mfma_f32_16x16x32_bf16 v[108:111], a[152:155], a[100:103], v[108:111]
    ds_read_b64_tr_b16 a[180:181], v20 offset:8192
    v_mfma_f32_16x16x32_bf16 v[104:107], a[152:155], a[96:99], v[104:107]
    ds_read_b64_tr_b16 a[182:183], v20 offset:9216
    s_waitcnt vmcnt(10)
    s_barrier
    s_waitcnt lgkmcnt(6)
    v_mfma_f32_16x16x32_bf16 v[60:63], a[156:159], a[108:111], v[60:63]
    ds_read_b64_tr_b16 a[128:129], v14 offset:16384
    v_mfma_f32_16x16x32_bf16 v[56:59], a[156:159], a[104:107], v[56:59]
    ds_read_b64_tr_b16 a[130:131], v14 offset:17408
    v_mfma_f32_16x16x32_bf16 v[68:71], a[160:163], a[108:111], v[68:71]
    ds_read_b64_tr_b16 a[132:133], v15 offset:16384
    buffer_load_short_d16_hi v45, v28, s[16:19], s24 offen
    v_mfma_f32_16x16x32_bf16 v[64:67], a[160:163], a[104:107], v[64:67]
    ds_read_b64_tr_b16 a[134:135], v15 offset:17408
    v_mfma_f32_16x16x32_bf16 v[76:79], a[164:167], a[108:111], v[76:79]
    ds_read_b64_tr_b16 a[136:137], v16 offset:16384
    v_mfma_f32_16x16x32_bf16 v[72:75], a[164:167], a[104:107], v[72:75]
    ds_read_b64_tr_b16 a[138:139], v16 offset:17408
    v_mfma_f32_16x16x32_bf16 v[84:87], a[168:171], a[108:111], v[84:87]
    ds_read_b64_tr_b16 a[140:141], v17 offset:16384
    v_mfma_f32_16x16x32_bf16 v[80:83], a[168:171], a[104:107], v[80:83]
    ds_read_b64_tr_b16 a[142:143], v17 offset:17408
    buffer_load_short_d16_hi v53, v28, s[20:23], s24 offen
    s_add_u32 s24, s24, 32896
    s_waitcnt lgkmcnt(8)
    v_mfma_f32_16x16x32_bf16 v[92:95], a[172:175], a[108:111], v[92:95]
    ds_read_b64_tr_b16 a[144:145], v18 offset:16384
    v_mfma_f32_16x16x32_bf16 v[88:91], a[172:175], a[104:107], v[88:91]
    ds_read_b64_tr_b16 a[146:147], v18 offset:17408
    v_mfma_f32_16x16x32_bf16 v[100:103], a[176:179], a[108:111], v[100:103]
    ds_read_b64_tr_b16 a[148:149], v19 offset:16384
    v_mfma_f32_16x16x32_bf16 v[96:99], a[176:179], a[104:107], v[96:99]
    ds_read_b64_tr_b16 a[150:151], v19 offset:17408
    buffer_load_short_d16_hi v46, v28, s[16:19], s24 offen
    v_mfma_f32_16x16x32_bf16 v[108:111], a[180:183], a[108:111], v[108:111]
    ds_read_b64_tr_b16 a[152:153], v20 offset:16384
    v_mfma_f32_16x16x32_bf16 v[104:107], a[180:183], a[104:107], v[104:107]
    ds_read_b64_tr_b16 a[154:155], v20 offset:17408
    s_waitcnt lgkmcnt(6)
    v_mfma_f32_16x16x32_bf16 v[60:63], a[128:131], a[116:119], v[60:63]
    ds_read_b64_tr_b16 a[156:157], v14 offset:24576
    v_mfma_f32_16x16x32_bf16 v[56:59], a[128:131], a[112:115], v[56:59]
    ds_read_b64_tr_b16 a[158:159], v14 offset:25600
    v_mfma_f32_16x16x32_bf16 v[68:71], a[132:135], a[116:119], v[68:71]
    ds_read_b64_tr_b16 a[160:161], v15 offset:24576
    buffer_load_short_d16_hi v54, v28, s[20:23], s24 offen
    s_add_u32 s24, s24, 32896
    v_mfma_f32_16x16x32_bf16 v[64:67], a[132:135], a[112:115], v[64:67]
    ds_read_b64_tr_b16 a[162:163], v15 offset:25600
    v_mfma_f32_16x16x32_bf16 v[76:79], a[136:139], a[116:119], v[76:79]
    ds_read_b64_tr_b16 a[164:165], v16 offset:24576
    v_mfma_f32_16x16x32_bf16 v[72:75], a[136:139], a[112:115], v[72:75]
    ds_read_b64_tr_b16 a[166:167], v16 offset:25600
    v_mfma_f32_16x16x32_bf16 v[84:87], a[140:143], a[116:119], v[84:87]
    ds_read_b64_tr_b16 a[168:169], v17 offset:24576
    v_mfma_f32_16x16x32_bf16 v[80:83], a[140:143], a[112:115], v[80:83]
    ds_read_b64_tr_b16 a[170:171], v17 offset:25600
    buffer_load_short_d16_hi v47, v28, s[16:19], s24 offen
    s_waitcnt lgkmcnt(8)
    v_mfma_f32_16x16x32_bf16 v[92:95], a[144:147], a[116:119], v[92:95]
    ds_read_b64_tr_b16 a[172:173], v18 offset:24576
    v_mfma_f32_16x16x32_bf16 v[88:91], a[144:147], a[112:115], v[88:91]
    ds_read_b64_tr_b16 a[174:175], v18 offset:25600
    v_mfma_f32_16x16x32_bf16 v[100:103], a[148:151], a[116:119], v[100:103]
    ds_read_b64_tr_b16 a[176:177], v19 offset:24576
    v_mfma_f32_16x16x32_bf16 v[96:99], a[148:151], a[112:115], v[96:99]
    ds_read_b64_tr_b16 a[178:179], v19 offset:25600
    buffer_load_short_d16_hi v55, v28, s[20:23], s24 offen
    v_mfma_f32_16x16x32_bf16 v[108:111], a[152:155], a[116:119], v[108:111]
    ds_read_b64_tr_b16 a[180:181], v20 offset:24576
    v_mfma_f32_16x16x32_bf16 v[104:107], a[152:155], a[112:115], v[104:107]
    ds_read_b64_tr_b16 a[182:183], v20 offset:25600
    s_waitcnt lgkmcnt(6)
    v_mfma_f32_16x16x32_bf16 v[60:63], a[156:159], a[124:127], v[60:63]
    v_mfma_f32_16x16x32_bf16 v[56:59], a[156:159], a[120:123], v[56:59]
    buffer_load_dwordx4 v[112:115], v3, s[36:39], 0 offen
    v_mfma_f32_16x16x32_bf16 v[68:71], a[160:163], a[124:127], v[68:71]
    v_mfma_f32_16x16x32_bf16 v[64:67], a[160:163], a[120:123], v[64:67]
    v_mfma_f32_16x16x32_bf16 v[76:79], a[164:167], a[124:127], v[76:79]
    v_mfma_f32_16x16x32_bf16 v[72:75], a[164:167], a[120:123], v[72:75]
    buffer_load_dwordx4 v[116:119], v3, s[4:7], s77 offen
    v_mfma_f32_16x16x32_bf16 v[84:87], a[168:171], a[124:127], v[84:87]
    v_mfma_f32_16x16x32_bf16 v[80:83], a[168:171], a[120:123], v[80:83]
    s_waitcnt lgkmcnt(0)
    v_mfma_f32_16x16x32_bf16 v[92:95], a[172:175], a[124:127], v[92:95]
    buffer_load_dwordx4 v[120:123], v3, s[4:7], s78 offen
    v_mfma_f32_16x16x32_bf16 v[88:91], a[172:175], a[120:123], v[88:91]
    v_mfma_f32_16x16x32_bf16 v[100:103], a[176:179], a[124:127], v[100:103]
    v_mfma_f32_16x16x32_bf16 v[96:99], a[176:179], a[120:123], v[96:99]
    v_mfma_f32_16x16x32_bf16 v[108:111], a[180:183], a[124:127], v[108:111]
    buffer_load_dword v9, v3, s[32:35], 0 offen
    v_mfma_f32_16x16x32_bf16 v[104:107], a[180:183], a[120:123], v[104:107]
    v_bfe_u32 v22, v0, 2, 2
    v_lshl_add_u32 v22, v2, 3, v22
    v_and_b32 v23, 3, v0
    v_lshlrev_b32 v23, 4, v23
    v_lshl_add_u32 v22, v22, 6, v23
    v_add_u32 v21, s59, v22
    s_and_b32 s74, s2, 1
    s_lshl2_add_u32 s74, s74, s48
    s_mul_i32 s74, s74, 7
    s_lshl_b32 s75, s74, 6
    s_add_u32 s75, s75, 17829888
    v_min_u32 v12, 27, v0
    v_lshlrev_b32 v12, 4, v12
    buffer_load_dword v13, v12, s[8:11], s75 offen sc1
    s_lshl_b32 s66, s48, 10
    s_lshl_b32 s67, s62, 8
    s_add_u32 s66, s66, s67
    s_add_u32 s66, s66, 17825792
    s_mov_b32 s79, s66
    v_min_u32 v38, 15, v0
    v_lshlrev_b32 v38, 4, v38
    buffer_load_dword v39, v38, s[8:11], s79 offen sc1
    s_mov_b32 s94, 0xbdd2d3e8
    s_mov_b32 s95, 0xbdd2d3e8
    v_mov_b32 v24, 0xc0135761
    v_mov_b32 v25, 0xc0135761
    s_mul_i32 s66, s54, 56
    s_lshr_b32 s67, s52, 1
    s_mul_i32 s67, s67, 7
    s_add_u32 s66, s66, s67
    s_lshl_b32 s66, s66, 12
    s_lshl_b32 s67, s55, 11
    s_add_u32 s67, s67, 0
    s_add_u32 s66, s66, s67
    s_lshl_b32 s68, s56, 9
    s_add_u32 s68, s68, 12288
    s_add_u32 s68, s68, s66
    s_lshl_b32 s67, s56, 14
    s_add_u32 s66, s66, s67
    v_lshrrev_b32 v22, 5, v0
    v_and_b32 v23, 31, v0
    v_lshlrev_b32 v23, 4, v23
    v_lshl_add_u32 v22, v22, 10, v23
    v_pk_mul_f32 v[26:27], v[56:57], v[56:57]
    v_pk_mul_f32 v[28:29], v[58:59], v[58:59]
    v_pk_fma_f32 v[26:27], v[26:27], s[94:95], v[24:25]
    v_pk_fma_f32 v[28:29], v[28:29], s[94:95], v[24:25]
    v_pk_mul_f32 v[26:27], v[26:27], v[56:57]
    v_pk_mul_f32 v[28:29], v[28:29], v[58:59]
    v_exp_f32 v26, v26
    v_exp_f32 v27, v27
    v_exp_f32 v28, v28
    v_exp_f32 v29, v29
    v_pk_add_f32 v[26:27], v[26:27], 1.0 op_sel_hi:[1,0]
    v_pk_add_f32 v[28:29], v[28:29], 1.0 op_sel_hi:[1,0]
    v_rcp_f32 v26, v26
    v_rcp_f32 v27, v27
    v_rcp_f32 v28, v28
    v_rcp_f32 v29, v29
    v_pk_mul_f32 v[26:27], v[26:27], v[56:57]
    v_pk_mul_f32 v[28:29], v[28:29], v[58:59]
    v_cvt_pk_bf16_f32 v30, v26, v27
    v_cvt_pk_bf16_f32 v31, v28, v29
    v_pk_mul_f32 v[26:27], v[64:65], v[64:65]
    v_pk_mul_f32 v[28:29], v[66:67], v[66:67]
    v_pk_fma_f32 v[26:27], v[26:27], s[94:95], v[24:25]
    v_pk_fma_f32 v[28:29], v[28:29], s[94:95], v[24:25]
    v_pk_mul_f32 v[26:27], v[26:27], v[64:65]
    v_pk_mul_f32 v[28:29], v[28:29], v[66:67]
    v_exp_f32 v26, v26
    v_exp_f32 v27, v27
    v_exp_f32 v28, v28
    v_exp_f32 v29, v29
    v_pk_add_f32 v[26:27], v[26:27], 1.0 op_sel_hi:[1,0]
    v_pk_add_f32 v[28:29], v[28:29], 1.0 op_sel_hi:[1,0]
    v_rcp_f32 v26, v26
    v_rcp_f32 v27, v27
    v_rcp_f32 v28, v28
    v_rcp_f32 v29, v29
    v_pk_mul_f32 v[26:27], v[26:27], v[64:65]
    v_pk_mul_f32 v[28:29], v[28:29], v[66:67]
    v_cvt_pk_bf16_f32 v32, v26, v27
    v_cvt_pk_bf16_f32 v33, v28, v29
    buffer_store_dwordx4 v[30:33], v3, s[8:11], s66 offen offset:0 sc1
    s_lshr_b32 s70, s49, 1
    s_lshr_b32 s71, s50, 3
    s_lshl2_add_u32 s70, s70, s71
    s_and_b32 s72, s49, 1
    s_lshl1_add_u32 s63, s70, s72
    s_and_b32 s64, s50, 7
    s_xor_b32 s70, s64, s71
    s_and_b32 s70, s70, 1
    s_mul_i32 s71, s72, 229376
    s_mul_i32 s72, s70, 16384
    s_add_u32 s87, s71, s72
    s_mul_i32 s70, s70, 28672
    s_add_u32 s88, s87, 4096
    s_add_u32 s89, s88, 4096
    s_add_u32 s90, s89, 4096
    s_sub_u32 s90, s90, s70
    s_add_u32 s91, s90, 4096
    s_add_u32 s92, s91, 4096
    s_add_u32 s93, s92, 4096
    s_lshl_b32 s71, s71, 1
    s_sub_u32 s71, 229376, s71
    s_add_u32 s80, s87, s71
    s_add_u32 s81, s88, s71
    s_add_u32 s82, s89, s71
    s_add_u32 s83, s90, s71
    s_add_u32 s84, s91, s71
    s_add_u32 s85, s92, s71
    s_add_u32 s86, s93, s71
    v_pk_mul_f32 v[26:27], v[60:61], v[60:61]
    v_pk_mul_f32 v[28:29], v[62:63], v[62:63]
    v_pk_fma_f32 v[26:27], v[26:27], s[94:95], v[24:25]
    v_pk_fma_f32 v[28:29], v[28:29], s[94:95], v[24:25]
    v_pk_mul_f32 v[26:27], v[26:27], v[60:61]
    v_pk_mul_f32 v[28:29], v[28:29], v[62:63]
    v_exp_f32 v26, v26
    v_exp_f32 v27, v27
    v_exp_f32 v28, v28
    v_exp_f32 v29, v29
    v_pk_add_f32 v[26:27], v[26:27], 1.0 op_sel_hi:[1,0]
    v_pk_add_f32 v[28:29], v[28:29], 1.0 op_sel_hi:[1,0]
    v_rcp_f32 v26, v26
    v_rcp_f32 v27, v27
    v_rcp_f32 v28, v28
    v_rcp_f32 v29, v29
    v_pk_mul_f32 v[26:27], v[26:27], v[60:61]
    v_pk_mul_f32 v[28:29], v[28:29], v[62:63]
    v_cvt_pk_bf16_f32 v34, v26, v27
    v_cvt_pk_bf16_f32 v35, v28, v29
    v_pk_mul_f32 v[26:27], v[68:69], v[68:69]
    v_pk_mul_f32 v[28:29], v[70:71], v[70:71]
    v_pk_fma_f32 v[26:27], v[26:27], s[94:95], v[24:25]
    v_pk_fma_f32 v[28:29], v[28:29], s[94:95], v[24:25]
    v_pk_mul_f32 v[26:27], v[26:27], v[68:69]
    v_pk_mul_f32 v[28:29], v[28:29], v[70:71]
    v_exp_f32 v26, v26
    v_exp_f32 v27, v27
    v_exp_f32 v28, v28
    v_exp_f32 v29, v29
    v_pk_add_f32 v[26:27], v[26:27], 1.0 op_sel_hi:[1,0]
    v_pk_add_f32 v[28:29], v[28:29], 1.0 op_sel_hi:[1,0]
    v_rcp_f32 v26, v26
    v_rcp_f32 v27, v27
    v_rcp_f32 v28, v28
    v_rcp_f32 v29, v29
    v_pk_mul_f32 v[26:27], v[26:27], v[68:69]
    v_pk_mul_f32 v[28:29], v[28:29], v[70:71]
    v_cvt_pk_bf16_f32 v36, v26, v27
    v_cvt_pk_bf16_f32 v37, v28, v29
    buffer_store_dwordx4 v[34:37], v3, s[8:11], s66 offen offset:1024 sc1
    s_mov_b32 s74, s66
    s_waitcnt vmcnt(2)
    v_cmp_ne_u32 vcc, s101, v39
    s_nop 1
    s_cbranch_vccnz L_poll_10
L_polled_11:
    s_or_b32 s67, s62, s48
    s_cbranch_scc1 L_nozc_12
    s_sub_u32 s66, 32, s61
    s_and_b32 s66, s66, 31
    s_lshl_b32 s66, s66, 16
    s_add_u32 s66, s66, 10485760
    s_add_u32 m0, s59, 4096
    s_nop 0
    buffer_load_dwordx4 v3, s[8:11], s66 offen offset:0 sc1 lds
    buffer_load_dwordx4 v3, s[8:11], s66 offen offset:1024 sc1 lds
    buffer_load_dwordx4 v3, s[8:11], s66 offen offset:2048 sc1 lds
    buffer_load_dwordx4 v3, s[8:11], s66 offen offset:3072 sc1 lds
L_nozc_12:
    s_and_b32 s66, s61, 31
    s_lshl_b32 s66, s66, 4
    s_lshl_b32 s67, s48, 2
    s_add_u32 s66, s66, s67
    s_add_u32 s66, s66, s62
    s_lshl_b32 s66, s66, 12
    s_add_u32 s66, s66, 10485760
    s_add_u32 m0, s59, 0
    s_nop 0
    buffer_load_dwordx4 v3, s[8:11], s66 offen offset:0 sc1 lds
    buffer_load_dwordx4 v3, s[8:11], s66 offen offset:1024 sc1 lds
    buffer_load_dwordx4 v3, s[8:11], s66 offen offset:2048 sc1 lds
    buffer_load_dwordx4 v3, s[8:11], s66 offen offset:3072 sc1 lds
    s_mov_b32 s66, s74
    v_mov_b32 v124, 0
    v_mov_b32 v125, 0
    v_dot2c_f32_bf16 v124, v112, v116
    v_dot2c_f32_bf16 v125, v112, v120
    v_dot2c_f32_bf16 v124, v113, v117
    v_dot2c_f32_bf16 v125, v113, v121
    v_dot2c_f32_bf16 v124, v114, v118
    v_dot2c_f32_bf16 v125, v114, v122
    v_dot2c_f32_bf16 v124, v115, v119
    v_dot2c_f32_bf16 v125, v115, v123
    s_nop 2
    v_add_f32_dpp v124, v124, v124 row_shr:1 row_mask:0xf bank_mask:0xf
    v_add_f32_dpp v125, v125, v125 row_shr:1 row_mask:0xf bank_mask:0xf
    s_nop 0
    v_add_f32_dpp v124, v124, v124 row_shr:2 row_mask:0xf bank_mask:0xf
    v_add_f32_dpp v125, v125, v125 row_shr:2 row_mask:0xf bank_mask:0xf
    s_nop 0
    v_add_f32_dpp v124, v124, v124 row_shr:4 row_mask:0xf bank_mask:0xf
    v_add_f32_dpp v125, v125, v125 row_shr:4 row_mask:0xf bank_mask:0xf
    s_nop 0
    v_add_f32_dpp v124, v124, v124 row_shr:8 row_mask:0xf bank_mask:0xf
    v_add_f32_dpp v125, v125, v125 row_shr:8 row_mask:0xf bank_mask:0xf
    s_nop 0
    v_add_f32_dpp v124, v124, v124 row_bcast:15 row_mask:0xa bank_mask:0xf
    v_add_f32_dpp v125, v125, v125 row_bcast:15 row_mask:0xa bank_mask:0xf
    s_nop 0
    v_add_f32_dpp v124, v124, v124 row_bcast:31 row_mask:0xc bank_mask:0xf
    v_add_f32_dpp v125, v125, v125 row_bcast:31 row_mask:0xc bank_mask:0xf
    v_cvt_pk_bf16_f32 v124, v124, v125
    v_and_b32 v125, 0xffff0000, v124
    v_lshlrev_b32 v124, 16, v124
    v_mul_f32 v124, 0xbfb8aa3b, v124
    v_mul_f32 v125, 0xbfb8aa3b, v125
    v_exp_f32 v124, v124
    v_exp_f32 v125, v125
    v_add_f32 v124, 1.0, v124
    v_add_f32 v125, 1.0, v125
    v_rcp_f32 v124, v124
    v_rcp_f32 v125, v125
    s_nop 0
    v_cvt_pk_bf16_f32 v124, v124, v125
    v_and_b32 v125, 0xffff0000, v124
    v_lshlrev_b32 v124, 16, v124
    v_cmp_eq_u32 vcc, 63, v0
    v_mov_b32 v126, 268435456
    s_nop 0
    v_cndmask_b32 v126, v126, 0, vcc
    buffer_store_dwordx2 v[124:125], v126, s[8:11], s99 offen sc1
    v_cmp_ne_u32 vcc, s101, v13
    s_nop 1
    s_cbranch_vccnz L_poll_13
L_polled_14:
    s_mov_b32 s74, s66
    s_and_b32 s67, s2, 1
    s_lshl2_add_u32 s67, s67, s48
    s_mul_i32 s67, s67, 7
    s_mul_i32 s66, s64, 56
    s_add_u32 s66, s66, s67
    s_and_b32 s67, s2, 1
    s_mul_i32 s67, s67, 56
    s_add_u32 s66, s66, s67
    s_lshl_b32 s66, s66, 12
    s_add_u32 s66, s66, 8159232
    v_add_u32 v4, s66, v3
    s_mov_b32 s66, s74
    buffer_load_dwordx4 a[0:3], v4, s[8:11], s80 offen offset:0 sc1
    buffer_load_dwordx4 a[4:7], v4, s[8:11], s80 offen offset:1024 sc1
    buffer_load_dwordx4 a[8:11], v4, s[8:11], s80 offen offset:2048 sc1
    buffer_load_dwordx4 a[12:15], v4, s[8:11], s80 offen offset:3072 sc1
    s_add_u32 s66, s66, 4096
    v_pk_mul_f32 v[26:27], v[72:73], v[72:73]
    v_pk_mul_f32 v[28:29], v[74:75], v[74:75]
    v_pk_fma_f32 v[26:27], v[26:27], s[94:95], v[24:25]
    v_pk_fma_f32 v[28:29], v[28:29], s[94:95], v[24:25]
    v_pk_mul_f32 v[26:27], v[26:27], v[72:73]
    v_pk_mul_f32 v[28:29], v[28:29], v[74:75]
    v_exp_f32 v26, v26
    v_exp_f32 v27, v27
    v_exp_f32 v28, v28
    v_exp_f32 v29, v29
    v_pk_add_f32 v[26:27], v[26:27], 1.0 op_sel_hi:[1,0]
    v_pk_add_f32 v[28:29], v[28:29], 1.0 op_sel_hi:[1,0]
    v_rcp_f32 v26, v26
    v_rcp_f32 v27, v27
    v_rcp_f32 v28, v28
    v_rcp_f32 v29, v29
    v_pk_mul_f32 v[26:27], v[26:27], v[72:73]
    v_pk_mul_f32 v[28:29], v[28:29], v[74:75]
    v_cvt_pk_bf16_f32 v30, v26, v27
    v_cvt_pk_bf16_f32 v31, v28, v29
    v_pk_mul_f32 v[26:27], v[80:81], v[80:81]
    v_pk_mul_f32 v[28:29], v[82:83], v[82:83]
    v_pk_fma_f32 v[26:27], v[26:27], s[94:95], v[24:25]
    v_pk_fma_f32 v[28:29], v[28:29], s[94:95], v[24:25]
    v_pk_mul_f32 v[26:27], v[26:27], v[80:81]
    v_pk_mul_f32 v[28:29], v[28:29], v[82:83]
    v_exp_f32 v26, v26
    v_exp_f32 v27, v27
    v_exp_f32 v28, v28
    v_exp_f32 v29, v29
    v_pk_add_f32 v[26:27], v[26:27], 1.0 op_sel_hi:[1,0]
    v_pk_add_f32 v[28:29], v[28:29], 1.0 op_sel_hi:[1,0]
    v_rcp_f32 v26, v26
    v_rcp_f32 v27, v27
    v_rcp_f32 v28, v28
    v_rcp_f32 v29, v29
    v_pk_mul_f32 v[26:27], v[26:27], v[80:81]
    v_pk_mul_f32 v[28:29], v[28:29], v[82:83]
    v_cvt_pk_bf16_f32 v32, v26, v27
    v_cvt_pk_bf16_f32 v33, v28, v29
    buffer_store_dwordx4 v[30:33], v3, s[8:11], s66 offen offset:0 sc1
    v_lshl_add_u32 v144, v1, 6, s61
    v_cvt_f32_u32 v144, v144
    v_mul_f32 v144, 0x3a000000, v144
    v_lshlrev_b32 v145, 3, v2
    v_cvt_f32_u32 v145, v145
    v_mul_f32 v145, v145, v144
    v_cos_f32 v148, v145
    v_sin_f32 v149, v145
    v_add_f32 v156, v145, v144
    v_add_f32 v157, v144, v144
    v_cos_f32 v150, v156
    v_sin_f32 v151, v156
    v_cos_f32 v152, v157
    v_sin_f32 v153, v157
    v_mul_f32 v156, 0x41d00000, v144
    v_cos_f32 v154, v156
    v_sin_f32 v155, v156
    v_cvt_pk_bf16_f32 v176, v148, v150
    v_cvt_pk_bf16_f32 v192, v149, v151
    v_xor_b32 v184, 0x80000000, v176
    v_xor_b32 v200, 0x80000000, v192
    v_pk_mul_f32 v[156:157], v[148:149], v[152:153] op_sel_hi:[1,0]
    v_pk_mul_f32 v[158:159], v[150:151], v[152:153] op_sel_hi:[1,0]
    v_pk_fma_f32 v[148:149], v[148:149], v[152:153], v[156:157] op_sel:[1,1,0] op_sel_hi:[0,1,1] neg_lo:[1,0,0]
    v_pk_fma_f32 v[150:151], v[150:151], v[152:153], v[158:159] op_sel:[1,1,0] op_sel_hi:[0,1,1] neg_lo:[1,0,0]
    v_cvt_pk_bf16_f32 v177, v148, v150
    v_cvt_pk_bf16_f32 v193, v149, v151
    v_xor_b32 v185, 0x80000000, v177
    v_xor_b32 v201, 0x80000000, v193
    v_pk_mul_f32 v[156:157], v[148:149], v[152:153] op_sel_hi:[1,0]
    v_pk_mul_f32 v[158:159], v[150:151], v[152:153] op_sel_hi:[1,0]
    v_pk_fma_f32 v[148:149], v[148:149], v[152:153], v[156:157] op_sel:[1,1,0] op_sel_hi:[0,1,1] neg_lo:[1,0,0]
    v_pk_fma_f32 v[150:151], v[150:151], v[152:153], v[158:159] op_sel:[1,1,0] op_sel_hi:[0,1,1] neg_lo:[1,0,0]
    v_cvt_pk_bf16_f32 v178, v148, v150
    v_cvt_pk_bf16_f32 v194, v149, v151
    v_xor_b32 v186, 0x80000000, v178
    v_xor_b32 v202, 0x80000000, v194
    v_pk_mul_f32 v[156:157], v[148:149], v[152:153] op_sel_hi:[1,0]
    v_pk_mul_f32 v[158:159], v[150:151], v[152:153] op_sel_hi:[1,0]
    v_pk_fma_f32 v[148:149], v[148:149], v[152:153], v[156:157] op_sel:[1,1,0] op_sel_hi:[0,1,1] neg_lo:[1,0,0]
    v_pk_fma_f32 v[150:151], v[150:151], v[152:153], v[158:159] op_sel:[1,1,0] op_sel_hi:[0,1,1] neg_lo:[1,0,0]
    v_cvt_pk_bf16_f32 v179, v148, v150
    v_cvt_pk_bf16_f32 v195, v149, v151
    v_xor_b32 v187, 0x80000000, v179
    v_xor_b32 v203, 0x80000000, v195
    v_pk_mul_f32 v[156:157], v[148:149], v[154:155] op_sel_hi:[1,0]
    v_pk_mul_f32 v[158:159], v[150:151], v[154:155] op_sel_hi:[1,0]
    v_pk_fma_f32 v[148:149], v[148:149], v[154:155], v[156:157] op_sel:[1,1,0] op_sel_hi:[0,1,1] neg_lo:[1,0,0]
    v_pk_fma_f32 v[150:151], v[150:151], v[154:155], v[158:159] op_sel:[1,1,0] op_sel_hi:[0,1,1] neg_lo:[1,0,0]
    v_cvt_pk_bf16_f32 v180, v148, v150
    v_cvt_pk_bf16_f32 v196, v149, v151
    v_xor_b32 v188, 0x80000000, v180
    v_xor_b32 v204, 0x80000000, v196
    v_pk_mul_f32 v[156:157], v[148:149], v[152:153] op_sel_hi:[1,0]
    v_pk_mul_f32 v[158:159], v[150:151], v[152:153] op_sel_hi:[1,0]
    v_pk_fma_f32 v[148:149], v[148:149], v[152:153], v[156:157] op_sel:[1,1,0] op_sel_hi:[0,1,1] neg_lo:[1,0,0]
    v_pk_fma_f32 v[150:151], v[150:151], v[152:153], v[158:159] op_sel:[1,1,0] op_sel_hi:[0,1,1] neg_lo:[1,0,0]
    v_cvt_pk_bf16_f32 v181, v148, v150
    v_cvt_pk_bf16_f32 v197, v149, v151
    v_xor_b32 v189, 0x80000000, v181
    v_xor_b32 v205, 0x80000000, v197
    v_pk_mul_f32 v[156:157], v[148:149], v[152:153] op_sel_hi:[1,0]
    v_pk_mul_f32 v[158:159], v[150:151], v[152:153] op_sel_hi:[1,0]
    v_pk_fma_f32 v[148:149], v[148:149], v[152:153], v[156:157] op_sel:[1,1,0] op_sel_hi:[0,1,1] neg_lo:[1,0,0]
    v_pk_fma_f32 v[150:151], v[150:151], v[152:153], v[158:159] op_sel:[1,1,0] op_sel_hi:[0,1,1] neg_lo:[1,0,0]
    v_cvt_pk_bf16_f32 v182, v148, v150
    v_cvt_pk_bf16_f32 v198, v149, v151
    v_xor_b32 v190, 0x80000000, v182
    v_xor_b32 v206, 0x80000000, v198
    v_pk_mul_f32 v[156:157], v[148:149], v[152:153] op_sel_hi:[1,0]
    v_pk_mul_f32 v[158:159], v[150:151], v[152:153] op_sel_hi:[1,0]
    v_pk_fma_f32 v[148:149], v[148:149], v[152:153], v[156:157] op_sel:[1,1,0] op_sel_hi:[0,1,1] neg_lo:[1,0,0]
    v_pk_fma_f32 v[150:151], v[150:151], v[152:153], v[158:159] op_sel:[1,1,0] op_sel_hi:[0,1,1] neg_lo:[1,0,0]
    v_cvt_pk_bf16_f32 v183, v148, v150
    v_cvt_pk_bf16_f32 v199, v149, v151
    v_xor_b32 v191, 0x80000000, v183
    v_xor_b32 v207, 0x80000000, v199
    buffer_load_dwordx4 a[16:19], v4, s[8:11], s81 offen offset:0 sc1
    buffer_load_dwordx4 a[20:23], v4, s[8:11], s81 offen offset:1024 sc1
    buffer_load_dwordx4 a[24:27], v4, s[8:11], s81 offen offset:2048 sc1
    buffer_load_dwordx4 a[28:31], v4, s[8:11], s81 offen offset:3072 sc1
    v_pk_mul_f32 v[26:27], v[76:77], v[76:77]
    v_pk_mul_f32 v[28:29], v[78:79], v[78:79]
    v_pk_fma_f32 v[26:27], v[26:27], s[94:95], v[24:25]
    v_pk_fma_f32 v[28:29], v[28:29], s[94:95], v[24:25]
    v_pk_mul_f32 v[26:27], v[26:27], v[76:77]
    v_pk_mul_f32 v[28:29], v[28:29], v[78:79]
    v_exp_f32 v26, v26
    v_exp_f32 v27, v27
    v_exp_f32 v28, v28
    v_exp_f32 v29, v29
    v_pk_add_f32 v[26:27], v[26:27], 1.0 op_sel_hi:[1,0]
    v_pk_add_f32 v[28:29], v[28:29], 1.0 op_sel_hi:[1,0]
    v_rcp_f32 v26, v26
    v_rcp_f32 v27, v27
    v_rcp_f32 v28, v28
    v_rcp_f32 v29, v29
    v_pk_mul_f32 v[26:27], v[26:27], v[76:77]
    v_pk_mul_f32 v[28:29], v[28:29], v[78:79]
    v_cvt_pk_bf16_f32 v34, v26, v27
    v_cvt_pk_bf16_f32 v35, v28, v29
    v_pk_mul_f32 v[26:27], v[84:85], v[84:85]
    v_pk_mul_f32 v[28:29], v[86:87], v[86:87]
    v_pk_fma_f32 v[26:27], v[26:27], s[94:95], v[24:25]
    v_pk_fma_f32 v[28:29], v[28:29], s[94:95], v[24:25]
    v_pk_mul_f32 v[26:27], v[26:27], v[84:85]
    v_pk_mul_f32 v[28:29], v[28:29], v[86:87]
    v_exp_f32 v26, v26
    v_exp_f32 v27, v27
    v_exp_f32 v28, v28
    v_exp_f32 v29, v29
    v_pk_add_f32 v[26:27], v[26:27], 1.0 op_sel_hi:[1,0]
    v_pk_add_f32 v[28:29], v[28:29], 1.0 op_sel_hi:[1,0]
    v_rcp_f32 v26, v26
    v_rcp_f32 v27, v27
    v_rcp_f32 v28, v28
    v_rcp_f32 v29, v29
    v_pk_mul_f32 v[26:27], v[26:27], v[84:85]
    v_pk_mul_f32 v[28:29], v[28:29], v[86:87]
    v_cvt_pk_bf16_f32 v36, v26, v27
    v_cvt_pk_bf16_f32 v37, v28, v29
    buffer_store_dwordx4 v[34:37], v3, s[8:11], s66 offen offset:1024 sc1
    v_and_b32 v146, 1, v1
    v_mul_u32_u24 v146, 0x8000, v146
    v_lshl_or_b32 v146, v146, 16, v146
    v_lshl_add_u32 v147, v2, 8, s61
    v_cvt_f32_u32 v147, v147
    v_mul_f32 v147, 0x3c800000, v147
    v_add_u32 v144, 0, v1
    v_cvt_f32_u32 v144, v144
    v_mul_f32 v144, 0x3d000000, v144
    v_mul_f32 v145, v147, v144
    v_cos_f32 v148, v145
    v_sin_f32 v150, v145
    v_add_f32 v145, v145, v144
    v_cos_f32 v149, v145
    v_sin_f32 v151, v145
    v_cvt_pk_bf16_f32 v208, v148, v149
    v_cvt_pk_bf16_f32 v216, v150, v151
    v_xor_b32 v210, v146, v208
    v_xor_b32 v218, v146, v216
    v_add_f32 v145, v145, v144
    v_cos_f32 v148, v145
    v_sin_f32 v150, v145
    v_add_f32 v145, v145, v144
    v_cos_f32 v149, v145
    v_sin_f32 v151, v145
    v_cvt_pk_bf16_f32 v209, v148, v149
    v_cvt_pk_bf16_f32 v217, v150, v151
    v_xor_b32 v211, v146, v209
    v_xor_b32 v219, v146, v217
    v_add_u32 v144, 16, v1
    v_cvt_f32_u32 v144, v144
    v_mul_f32 v144, 0x3d000000, v144
    v_mul_f32 v145, v147, v144
    v_cos_f32 v148, v145
    v_sin_f32 v150, v145
    v_add_f32 v145, v145, v144
    v_cos_f32 v149, v145
    v_sin_f32 v151, v145
    v_cvt_pk_bf16_f32 v212, v148, v149
    v_cvt_pk_bf16_f32 v220, v150, v151
    v_xor_b32 v214, v146, v212
    v_xor_b32 v222, v146, v220
    v_add_f32 v145, v145, v144
    v_cos_f32 v148, v145
    v_sin_f32 v150, v145
    v_add_f32 v145, v145, v144
    v_cos_f32 v149, v145
    v_sin_f32 v151, v145
    v_cvt_pk_bf16_f32 v213, v148, v149
    v_cvt_pk_bf16_f32 v221, v150, v151
    v_xor_b32 v215, v146, v213
    v_xor_b32 v223, v146, v221
    v_lshl_add_u32 v146, v2, 4, s62
    v_cmp_eq_u32 vcc, 0, v146
    v_cvt_f32_u32 v146, v146
    v_mul_f32 v146, 0x3e800000, v146
    v_mov_b32 v147, 0.5
    v_and_b32 v160, 1, v1
    v_cmp_eq_u32 s[72:73], 1, v160
    v_add_u32 v161, 1, v1
    v_bfe_u32 v161, v161, 1, 1
    v_mul_u32_u24 v161, 0x8000, v161
    v_lshl_or_b32 v161, v161, 16, v161
    v_bfe_u32 v162, v1, 1, 1
    v_mul_u32_u24 v162, 0x8000, v162
    v_lshl_or_b32 v162, v162, 16, v162
    v_lshlrev_b32 v160, 31, v160
    v_xor_b32 v160, 0xbf000000, v160
    s_lshl_b32 s70, s48, 5
    v_add_u32 v144, s70, v1
    v_cvt_f32_u32 v144, v144
    v_mul_f32 v144, 0x3c000000, v144
    v_mul_f32 v145, v146, v144
    v_cos_f32 v148, v145
    v_sin_f32 v149, v145
    v_add_f32 v156, v145, v144
    v_add_f32 v157, v144, v144
    v_cos_f32 v150, v156
    v_sin_f32 v151, v156
    v_cos_f32 v152, v157
    v_sin_f32 v153, v157
    v_mul_f32 v156, 0x41600000, v144
    v_cos_f32 v154, v156
    v_sin_f32 v155, v156
    v_cvt_pk_bf16_f32 v224, v148, v150
    v_cvt_pk_bf16_f32 v240, v149, v151
    v_cndmask_b32 v228, v224, v240, s[72:73]
    v_cndmask_b32 v244, v240, v224, s[72:73]
    v_xor_b32 v228, v161, v228
    v_xor_b32 v244, v162, v244
    v_cndmask_b32 v156, v148, v147, vcc
    v_cndmask_b32 v157, v149, v160, vcc
    v_cvt_pk_bf16_f32 v224, v156, v150
    v_cvt_pk_bf16_f32 v240, v157, v151
    v_pk_mul_f32 v[156:157], v[148:149], v[152:153] op_sel_hi:[1,0]
    v_pk_mul_f32 v[158:159], v[150:151], v[152:153] op_sel_hi:[1,0]
    v_pk_fma_f32 v[148:149], v[148:149], v[152:153], v[156:157] op_sel:[1,1,0] op_sel_hi:[0,1,1] neg_lo:[1,0,0]
    v_pk_fma_f32 v[150:151], v[150:151], v[152:153], v[158:159] op_sel:[1,1,0] op_sel_hi:[0,1,1] neg_lo:[1,0,0]
    v_cvt_pk_bf16_f32 v225, v148, v150
    v_cvt_pk_bf16_f32 v241, v149, v151
    v_cndmask_b32 v229, v225, v241, s[72:73]
    v_cndmask_b32 v245, v241, v225, s[72:73]
    v_xor_b32 v229, v161, v229
    v_xor_b32 v245, v162, v245
    v_pk_mul_f32 v[156:157], v[148:149], v[154:155] op_sel_hi:[1,0]
    v_pk_mul_f32 v[158:159], v[150:151], v[154:155] op_sel_hi:[1,0]
    v_pk_fma_f32 v[148:149], v[148:149], v[154:155], v[156:157] op_sel:[1,1,0] op_sel_hi:[0,1,1] neg_lo:[1,0,0]
    v_pk_fma_f32 v[150:151], v[150:151], v[154:155], v[158:159] op_sel:[1,1,0] op_sel_hi:[0,1,1] neg_lo:[1,0,0]
    v_cvt_pk_bf16_f32 v226, v148, v150
    v_cvt_pk_bf16_f32 v242, v149, v151
    v_cndmask_b32 v230, v226, v242, s[72:73]
    v_cndmask_b32 v246, v242, v226, s[72:73]
    v_xor_b32 v230, v161, v230
    v_xor_b32 v246, v162, v246
    v_pk_mul_f32 v[156:157], v[148:149], v[152:153] op_sel_hi:[1,0]
    v_pk_mul_f32 v[158:159], v[150:151], v[152:153] op_sel_hi:[1,0]
    v_pk_fma_f32 v[148:149], v[148:149], v[152:153], v[156:157] op_sel:[1,1,0] op_sel_hi:[0,1,1] neg_lo:[1,0,0]
    v_pk_fma_f32 v[150:151], v[150:151], v[152:153], v[158:159] op_sel:[1,1,0] op_sel_hi:[0,1,1] neg_lo:[1,0,0]
    v_cvt_pk_bf16_f32 v227, v148, v150
    v_cvt_pk_bf16_f32 v243, v149, v151
    v_cndmask_b32 v231, v227, v243, s[72:73]
    v_cndmask_b32 v247, v243, v227, s[72:73]
    v_xor_b32 v231, v161, v231
    v_xor_b32 v247, v162, v247
    s_add_u32 s70, s70, 16
    v_add_u32 v144, s70, v1
    v_cvt_f32_u32 v144, v144
    v_mul_f32 v144, 0x3c000000, v144
    v_mul_f32 v145, v146, v144
    v_cos_f32 v148, v145
    v_sin_f32 v149, v145
    v_add_f32 v156, v145, v144
    v_add_f32 v157, v144, v144
    v_cos_f32 v150, v156
    v_sin_f32 v151, v156
    v_cos_f32 v152, v157
    v_sin_f32 v153, v157
    v_mul_f32 v156, 0x41600000, v144
    v_cos_f32 v154, v156
    v_sin_f32 v155, v156
    v_cvt_pk_bf16_f32 v232, v148, v150
    v_cvt_pk_bf16_f32 v248, v149, v151
    v_cndmask_b32 v236, v232, v248, s[72:73]
    v_cndmask_b32 v252, v248, v232, s[72:73]
    v_xor_b32 v236, v161, v236
    v_xor_b32 v252, v162, v252
    v_cndmask_b32 v156, v148, v147, vcc
    v_cndmask_b32 v157, v149, v160, vcc
    v_cvt_pk_bf16_f32 v232, v156, v150
    v_cvt_pk_bf16_f32 v248, v157, v151
    v_pk_mul_f32 v[156:157], v[148:149], v[152:153] op_sel_hi:[1,0]
    v_pk_mul_f32 v[158:159], v[150:151], v[152:153] op_sel_hi:[1,0]
    v_pk_fma_f32 v[148:149], v[148:149], v[152:153], v[156:157] op_sel:[1,1,0] op_sel_hi:[0,1,1] neg_lo:[1,0,0]
    v_pk_fma_f32 v[150:151], v[150:151], v[152:153], v[158:159] op_sel:[1,1,0] op_sel_hi:[0,1,1] neg_lo:[1,0,0]
    v_cvt_pk_bf16_f32 v233, v148, v150
    v_cvt_pk_bf16_f32 v249, v149, v151
    v_cndmask_b32 v237, v233, v249, s[72:73]
    v_cndmask_b32 v253, v249, v233, s[72:73]
    v_xor_b32 v237, v161, v237
    v_xor_b32 v253, v162, v253
    v_pk_mul_f32 v[156:157], v[148:149], v[154:155] op_sel_hi:[1,0]
    v_pk_mul_f32 v[158:159], v[150:151], v[154:155] op_sel_hi:[1,0]
    v_pk_fma_f32 v[148:149], v[148:149], v[154:155], v[156:157] op_sel:[1,1,0] op_sel_hi:[0,1,1] neg_lo:[1,0,0]
    v_pk_fma_f32 v[150:151], v[150:151], v[154:155], v[158:159] op_sel:[1,1,0] op_sel_hi:[0,1,1] neg_lo:[1,0,0]
    v_cvt_pk_bf16_f32 v234, v148, v150
    v_cvt_pk_bf16_f32 v250, v149, v151
    v_cndmask_b32 v238, v234, v250, s[72:73]
    v_cndmask_b32 v254, v250, v234, s[72:73]
    v_xor_b32 v238, v161, v238
    v_xor_b32 v254, v162, v254
    v_pk_mul_f32 v[156:157], v[148:149], v[152:153] op_sel_hi:[1,0]
    v_pk_mul_f32 v[158:159], v[150:151], v[152:153] op_sel_hi:[1,0]
    v_pk_fma_f32 v[148:149], v[148:149], v[152:153], v[156:157] op_sel:[1,1,0] op_sel_hi:[0,1,1] neg_lo:[1,0,0]
    v_pk_fma_f32 v[150:151], v[150:151], v[152:153], v[158:159] op_sel:[1,1,0] op_sel_hi:[0,1,1] neg_lo:[1,0,0]
    v_cvt_pk_bf16_f32 v235, v148, v150
    v_cvt_pk_bf16_f32 v251, v149, v151
    v_cndmask_b32 v239, v235, v251, s[72:73]
    v_cndmask_b32 v255, v251, v235, s[72:73]
    v_xor_b32 v239, v161, v239
    v_xor_b32 v255, v162, v255
    buffer_load_dwordx4 a[32:35], v4, s[8:11], s82 offen offset:0 sc1
    buffer_load_dwordx4 a[36:39], v4, s[8:11], s82 offen offset:1024 sc1
    buffer_load_dwordx4 a[40:43], v4, s[8:11], s82 offen offset:2048 sc1
    buffer_load_dwordx4 a[44:47], v4, s[8:11], s82 offen offset:3072 sc1
    s_add_u32 s66, s66, 4096
    v_pk_mul_f32 v[26:27], v[88:89], v[88:89]
    v_pk_mul_f32 v[28:29], v[90:91], v[90:91]
    v_pk_fma_f32 v[26:27], v[26:27], s[94:95], v[24:25]
    v_pk_fma_f32 v[28:29], v[28:29], s[94:95], v[24:25]
    v_pk_mul_f32 v[26:27], v[26:27], v[88:89]
    v_pk_mul_f32 v[28:29], v[28:29], v[90:91]
    v_exp_f32 v26, v26
    v_exp_f32 v27, v27
    v_exp_f32 v28, v28
    v_exp_f32 v29, v29
    v_pk_add_f32 v[26:27], v[26:27], 1.0 op_sel_hi:[1,0]
    v_pk_add_f32 v[28:29], v[28:29], 1.0 op_sel_hi:[1,0]
    v_rcp_f32 v26, v26
    v_rcp_f32 v27, v27
    v_rcp_f32 v28, v28
    v_rcp_f32 v29, v29
    v_pk_mul_f32 v[26:27], v[26:27], v[88:89]
    v_pk_mul_f32 v[28:29], v[28:29], v[90:91]
    v_cvt_pk_bf16_f32 v30, v26, v27
    v_cvt_pk_bf16_f32 v31, v28, v29
    v_pk_mul_f32 v[26:27], v[96:97], v[96:97]
    v_pk_mul_f32 v[28:29], v[98:99], v[98:99]
    v_pk_fma_f32 v[26:27], v[26:27], s[94:95], v[24:25]
    v_pk_fma_f32 v[28:29], v[28:29], s[94:95], v[24:25]
    v_pk_mul_f32 v[26:27], v[26:27], v[96:97]
    v_pk_mul_f32 v[28:29], v[28:29], v[98:99]
    v_exp_f32 v26, v26
    v_exp_f32 v27, v27
    v_exp_f32 v28, v28
    v_exp_f32 v29, v29
    v_pk_add_f32 v[26:27], v[26:27], 1.0 op_sel_hi:[1,0]
    v_pk_add_f32 v[28:29], v[28:29], 1.0 op_sel_hi:[1,0]
    v_rcp_f32 v26, v26
    v_rcp_f32 v27, v27
    v_rcp_f32 v28, v28
    v_rcp_f32 v29, v29
    v_pk_mul_f32 v[26:27], v[26:27], v[96:97]
    v_pk_mul_f32 v[28:29], v[28:29], v[98:99]
    v_cvt_pk_bf16_f32 v32, v26, v27
    v_cvt_pk_bf16_f32 v33, v28, v29
    buffer_store_dwordx4 v[30:33], v3, s[8:11], s66 offen offset:0 sc1
    s_or_b32 s70, s62, s48
    s_cbranch_scc1 L_noab_15
    s_waitcnt vmcnt(16)
    ds_read_b64_tr_b16 v[112:113], v21 offset:4096
    ds_read_b64_tr_b16 v[114:115], v21 offset:4352
    ds_read_b64_tr_b16 v[116:117], v21 offset:6144
    ds_read_b64_tr_b16 v[118:119], v21 offset:6400
    ds_read_b64_tr_b16 v[120:121], v21 offset:4104
    ds_read_b64_tr_b16 v[122:123], v21 offset:4360
    ds_read_b64_tr_b16 v[124:125], v21 offset:6152
    ds_read_b64_tr_b16 v[126:127], v21 offset:6408
    v_add_f32 v136, v136, v138
    v_sub_f32 v137, v137, v139
    v_add_f32 v140, v140, v142
    v_sub_f32 v141, v141, v143
    v_add_f32 v168, v136, v140
    v_add_f32 v169, v137, v141
    v_sub_f32 v170, v136, v140
    v_sub_f32 v171, v137, v141
    v_cmp_gt_u32 vcc, 32, v0
    v_mul_f32 v168, 0x3e800000, v168
    v_mul_f32 v169, 0x3e800000, v169
    v_mul_f32 v170, 0x3e800000, v170
    v_mul_f32 v171, 0x3e800000, v171
    v_cndmask_b32 v168, 0, v168, vcc
    v_cndmask_b32 v169, 0, v169, vcc
    v_cndmask_b32 v170, 0, v170, vcc
    v_cndmask_b32 v171, 0, v171, vcc
    ds_write_b128 v3, v[168:171] offset:8192
    v_lshlrev_b32 v136, 6, v2
    v_mov_b32 v137, 512
    v_cmp_eq_u32 vcc, 0, v1
    s_nop 1
    v_cndmask_b32 v136, v137, v136, vcc
    ds_read_b128 v[56:59], v136 offset:8192
    ds_read_b128 v[60:63], v136 offset:8208
    ds_read_b128 v[64:67], v136 offset:8224
    ds_read_b128 v[68:71], v136 offset:8240
    ds_read_b128 v[72:75], v136 offset:8448
    ds_read_b128 v[76:79], v136 offset:8464
    ds_read_b128 v[80:83], v136 offset:8480
    ds_read_b128 v[84:87], v136 offset:8496
    s_waitcnt lgkmcnt(8)
    v_xor_b32 v128, 0x80008000, v120
    v_xor_b32 v129, 0x80008000, v121
    v_xor_b32 v130, 0x80008000, v122
    v_xor_b32 v131, 0x80008000, v123
    v_xor_b32 v132, 0x80008000, v124
    v_xor_b32 v133, 0x80008000, v125
    v_xor_b32 v134, 0x80008000, v126
    v_xor_b32 v135, 0x80008000, v127
    v_mfma_f32_16x16x32_bf16 v[136:139], v[176:179], v[112:115], 0
    v_mfma_f32_16x16x32_bf16 v[140:143], v[176:179], v[120:123], 0
    v_mfma_f32_16x16x32_bf16 v[144:147], v[184:187], v[112:115], 0
    v_mfma_f32_16x16x32_bf16 v[148:151], v[184:187], v[120:123], 0
    v_mfma_f32_16x16x32_bf16 v[136:139], v[180:183], v[116:119], v[136:139]
    v_mfma_f32_16x16x32_bf16 v[140:143], v[180:183], v[124:127], v[140:143]
    v_mfma_f32_16x16x32_bf16 v[144:147], v[188:191], v[116:119], v[144:147]
    v_mfma_f32_16x16x32_bf16 v[148:151], v[188:191], v[124:127], v[148:151]
    v_mfma_f32_16x16x32_bf16 v[136:139], v[192:195], v[128:131], v[136:139]
    v_mfma_f32_16x16x32_bf16 v[140:143], v[192:195], v[112:115], v[140:143]
    v_mfma_f32_16x16x32_bf16 v[144:147], v[200:203], v[128:131], v[144:147]
    v_mfma_f32_16x16x32_bf16 v[148:151], v[200:203], v[112:115], v[148:151]
    v_mfma_f32_16x16x32_bf16 v[136:139], v[196:199], v[132:135], v[136:139]
    v_mfma_f32_16x16x32_bf16 v[140:143], v[196:199], v[116:119], v[140:143]
    v_mfma_f32_16x16x32_bf16 v[144:147], v[204:207], v[132:135], v[144:147]
    v_mfma_f32_16x16x32_bf16 v[148:151], v[204:207], v[116:119], v[148:151]
    s_waitcnt lgkmcnt(0)
    v_cndmask_b32 v40, v40, v56, vcc
    v_cndmask_b32 v48, v48, v57, vcc
    v_cndmask_b32 v41, v41, v60, vcc
    v_cndmask_b32 v49, v49, v61, vcc
    v_cndmask_b32 v42, v42, v64, vcc
    v_cndmask_b32 v50, v50, v65, vcc
    v_cndmask_b32 v43, v43, v68, vcc
    v_cndmask_b32 v51, v51, v69, vcc
    v_cndmask_b32 v44, v44, v72, vcc
    v_cndmask_b32 v52, v52, v73, vcc
    v_cndmask_b32 v45, v45, v76, vcc
    v_cndmask_b32 v53, v53, v77, vcc
    v_cndmask_b32 v46, v46, v80, vcc
    v_cndmask_b32 v54, v54, v81, vcc
    v_cndmask_b32 v47, v47, v84, vcc
    v_cndmask_b32 v55, v55, v85, vcc
    v_mul_f32 v152, v136, v58
    v_mul_f32 v156, v136, v59
    v_fmac_f32 v152, v140, v59
    v_fma_f32 v156, -v140, v58, v156
    v_mul_f32 v153, v137, v62
    v_mul_f32 v157, v137, v63
    v_fmac_f32 v153, v141, v63
    v_fma_f32 v157, -v141, v62, v157
    v_mul_f32 v154, v138, v66
    v_mul_f32 v158, v138, v67
    v_fmac_f32 v154, v142, v67
    v_fma_f32 v158, -v142, v66, v158
    v_mul_f32 v155, v139, v70
    v_mul_f32 v159, v139, v71
    v_fmac_f32 v155, v143, v71
    v_fma_f32 v159, -v143, v70, v159
    v_mul_f32 v160, v144, v74
    v_mul_f32 v164, v144, v75
    v_fmac_f32 v160, v148, v75
    v_fma_f32 v164, -v148, v74, v164
    v_mul_f32 v161, v145, v78
    v_mul_f32 v165, v145, v79
    v_fmac_f32 v161, v149, v79
    v_fma_f32 v165, -v149, v78, v165
    v_mul_f32 v162, v146, v82
    v_mul_f32 v166, v146, v83
    v_fmac_f32 v162, v150, v83
    v_fma_f32 v166, -v150, v82, v166
    v_mul_f32 v163, v147, v86
    v_mul_f32 v167, v147, v87
    v_fmac_f32 v163, v151, v87
    v_fma_f32 v167, -v151, v86, v167
L_noab_15:
    buffer_load_dwordx4 a[48:51], v4, s[8:11], s83 offen offset:0 sc1
    buffer_load_dwordx4 a[52:55], v4, s[8:11], s83 offen offset:1024 sc1
    buffer_load_dwordx4 a[56:59], v4, s[8:11], s83 offen offset:2048 sc1
    buffer_load_dwordx4 a[60:63], v4, s[8:11], s83 offen offset:3072 sc1
    v_pk_mul_f32 v[26:27], v[92:93], v[92:93]
    v_pk_mul_f32 v[28:29], v[94:95], v[94:95]
    v_pk_fma_f32 v[26:27], v[26:27], s[94:95], v[24:25]
    v_pk_fma_f32 v[28:29], v[28:29], s[94:95], v[24:25]
    v_pk_mul_f32 v[26:27], v[26:27], v[92:93]
    v_pk_mul_f32 v[28:29], v[28:29], v[94:95]
    v_exp_f32 v26, v26
    v_exp_f32 v27, v27
    v_exp_f32 v28, v28
    v_exp_f32 v29, v29
    v_pk_add_f32 v[26:27], v[26:27], 1.0 op_sel_hi:[1,0]
    v_pk_add_f32 v[28:29], v[28:29], 1.0 op_sel_hi:[1,0]
    v_rcp_f32 v26, v26
    v_rcp_f32 v27, v27
    v_rcp_f32 v28, v28
    v_rcp_f32 v29, v29
    v_pk_mul_f32 v[26:27], v[26:27], v[92:93]
    v_pk_mul_f32 v[28:29], v[28:29], v[94:95]
    v_cvt_pk_bf16_f32 v34, v26, v27
    v_cvt_pk_bf16_f32 v35, v28, v29
    v_pk_mul_f32 v[26:27], v[100:101], v[100:101]
    v_pk_mul_f32 v[28:29], v[102:103], v[102:103]
    v_pk_fma_f32 v[26:27], v[26:27], s[94:95], v[24:25]
    v_pk_fma_f32 v[28:29], v[28:29], s[94:95], v[24:25]
    v_pk_mul_f32 v[26:27], v[26:27], v[100:101]
    v_pk_mul_f32 v[28:29], v[28:29], v[102:103]
    v_exp_f32 v26, v26
    v_exp_f32 v27, v27
    v_exp_f32 v28, v28
    v_exp_f32 v29, v29
    v_pk_add_f32 v[26:27], v[26:27], 1.0 op_sel_hi:[1,0]
    v_pk_add_f32 v[28:29], v[28:29], 1.0 op_sel_hi:[1,0]
    v_rcp_f32 v26, v26
    v_rcp_f32 v27, v27
    v_rcp_f32 v28, v28
    v_rcp_f32 v29, v29
    v_pk_mul_f32 v[26:27], v[26:27], v[100:101]
    v_pk_mul_f32 v[28:29], v[28:29], v[102:103]
    v_cvt_pk_bf16_f32 v36, v26, v27
    v_cvt_pk_bf16_f32 v37, v28, v29
    buffer_store_dwordx4 v[34:37], v3, s[8:11], s66 offen offset:1024 sc1
    v_pk_mul_f32 v[26:27], v[104:105], v[104:105]
    v_pk_mul_f32 v[28:29], v[106:107], v[106:107]
    v_pk_fma_f32 v[26:27], v[26:27], s[94:95], v[24:25]
    v_pk_fma_f32 v[28:29], v[28:29], s[94:95], v[24:25]
    v_pk_mul_f32 v[26:27], v[26:27], v[104:105]
    v_pk_mul_f32 v[28:29], v[28:29], v[106:107]
    v_exp_f32 v26, v26
    v_exp_f32 v27, v27
    v_exp_f32 v28, v28
    v_exp_f32 v29, v29
    v_pk_add_f32 v[26:27], v[26:27], 1.0 op_sel_hi:[1,0]
    v_pk_add_f32 v[28:29], v[28:29], 1.0 op_sel_hi:[1,0]
    v_rcp_f32 v26, v26
    v_rcp_f32 v27, v27
    v_rcp_f32 v28, v28
    v_rcp_f32 v29, v29
    v_pk_mul_f32 v[26:27], v[26:27], v[104:105]
    v_pk_mul_f32 v[28:29], v[28:29], v[106:107]
    v_cvt_pk_bf16_f32 v30, v26, v27
    v_cvt_pk_bf16_f32 v31, v28, v29
    v_pk_mul_f32 v[26:27], v[108:109], v[108:109]
    v_pk_mul_f32 v[28:29], v[110:111], v[110:111]
    v_pk_fma_f32 v[26:27], v[26:27], s[94:95], v[24:25]
    v_pk_fma_f32 v[28:29], v[28:29], s[94:95], v[24:25]
    v_pk_mul_f32 v[26:27], v[26:27], v[108:109]
    v_pk_mul_f32 v[28:29], v[28:29], v[110:111]
    v_exp_f32 v26, v26
    v_exp_f32 v27, v27
    v_exp_f32 v28, v28
    v_exp_f32 v29, v29
    v_pk_add_f32 v[26:27], v[26:27], 1.0 op_sel_hi:[1,0]
    v_pk_add_f32 v[28:29], v[28:29], 1.0 op_sel_hi:[1,0]
    v_rcp_f32 v26, v26
    v_rcp_f32 v27, v27
    v_rcp_f32 v28, v28
    v_rcp_f32 v29, v29
    v_pk_mul_f32 v[26:27], v[26:27], v[108:109]
    v_pk_mul_f32 v[28:29], v[28:29], v[110:111]
    v_cvt_pk_bf16_f32 v32, v26, v27
    v_cvt_pk_bf16_f32 v33, v28, v29
    s_nop 0
    v_permlane32_swap_b32 v30, v32
    v_permlane32_swap_b32 v31, v33
    buffer_store_dwordx4 v[30:33], v22, s[8:11], s68 offen sc1
    s_and_b32 s67, s2, 1
    s_lshl2_add_u32 s67, s67, s48
    s_mul_i32 s67, s67, 7
    s_and_b32 s66, s63, 30
    s_mul_i32 s66, s66, 56
    s_add_u32 s66, s66, s67
    s_lshl_b32 s66, s66, 12
    s_add_u32 s66, s66, 0
    s_xor_b32 s67, s48, 0
    s_lshl_b32 s67, s67, 10
    s_add_u32 s67, s67, s66
    v_add_u32 v5, s67, v3
    s_xor_b32 s67, s48, 1
    s_lshl_b32 s67, s67, 10
    s_add_u32 s67, s67, s66
    v_add_u32 v6, s67, v3
    s_xor_b32 s67, s48, 2
    s_lshl_b32 s67, s67, 10
    s_add_u32 s67, s67, s66
    v_add_u32 v7, s67, v3
    s_xor_b32 s67, s48, 3
    s_lshl_b32 s67, s67, 10
    s_add_u32 s67, s67, s66
    v_add_u32 v8, s67, v3
    s_waitcnt vmcnt(22)
    ds_read_b64_tr_b16 v[112:113], v21 offset:0
    ds_read_b64_tr_b16 v[114:115], v21 offset:256
    ds_read_b64_tr_b16 v[116:117], v21 offset:2048
    ds_read_b64_tr_b16 v[118:119], v21 offset:2304
    ds_read_b64_tr_b16 v[120:121], v21 offset:8
    ds_read_b64_tr_b16 v[122:123], v21 offset:264
    ds_read_b64_tr_b16 v[124:125], v21 offset:2056
    ds_read_b64_tr_b16 v[126:127], v21 offset:2312
    s_waitcnt lgkmcnt(0)
    v_xor_b32 v128, 0x80008000, v112
    v_xor_b32 v129, 0x80008000, v113
    v_xor_b32 v130, 0x80008000, v114
    v_xor_b32 v131, 0x80008000, v115
    v_xor_b32 v132, 0x80008000, v116
    v_xor_b32 v133, 0x80008000, v117
    v_xor_b32 v134, 0x80008000, v118
    v_xor_b32 v135, 0x80008000, v119
    v_mfma_f32_16x16x32_bf16 v[136:139], v[176:179], v[112:115], 0
    v_mfma_f32_16x16x32_bf16 v[140:143], v[176:179], v[120:123], 0
    v_mfma_f32_16x16x32_bf16 v[144:147], v[184:187], v[112:115], 0
    v_mfma_f32_16x16x32_bf16 v[148:151], v[184:187], v[120:123], 0
    v_mfma_f32_16x16x32_bf16 v[136:139], v[180:183], v[116:119], v[136:139]
    v_mfma_f32_16x16x32_bf16 v[140:143], v[180:183], v[124:127], v[140:143]
    v_mfma_f32_16x16x32_bf16 v[144:147], v[188:191], v[116:119], v[144:147]
    v_mfma_f32_16x16x32_bf16 v[148:151], v[188:191], v[124:127], v[148:151]
    v_mfma_f32_16x16x32_bf16 v[136:139], v[192:195], v[120:123], v[136:139]
    v_mfma_f32_16x16x32_bf16 v[140:143], v[192:195], v[128:131], v[140:143]
    v_mfma_f32_16x16x32_bf16 v[144:147], v[200:203], v[120:123], v[144:147]
    v_mfma_f32_16x16x32_bf16 v[148:151], v[200:203], v[128:131], v[148:151]
    v_mfma_f32_16x16x32_bf16 v[136:139], v[196:199], v[124:127], v[136:139]
    v_mfma_f32_16x16x32_bf16 v[140:143], v[196:199], v[132:135], v[140:143]
    v_mfma_f32_16x16x32_bf16 v[144:147], v[204:207], v[124:127], v[144:147]
    v_mfma_f32_16x16x32_bf16 v[148:151], v[204:207], v[132:135], v[148:151]
    s_lshl_b32 s72, s54, 9
    s_lshl_b32 s73, s52, 5
    s_add_u32 s72, s72, s73
    s_lshl_b32 s73, s55, 4
    s_add_u32 s72, s72, s73
    s_add_u32 s72, s72, 17842176
    s_waitcnt vmcnt(0)
    s_mov_b32 s98, s101
    s_atomic_swap s98, s[8:9], s72 glc
    buffer_load_dwordx4 a[64:67], v4, s[8:11], s84 offen offset:0 sc1
    buffer_load_dwordx4 a[68:71], v4, s[8:11], s84 offen offset:1024 sc1
    buffer_load_dwordx4 a[72:75], v4, s[8:11], s84 offen offset:2048 sc1
    buffer_load_dwordx4 a[76:79], v4, s[8:11], s84 offen offset:3072 sc1
    buffer_load_dwordx4 a[80:83], v4, s[8:11], s85 offen offset:0 sc1
    buffer_load_dwordx4 a[84:87], v4, s[8:11], s85 offen offset:1024 sc1
    s_or_b32 s66, s62, s48
    s_cmp_eq_u32 s66, 0
    s_cbranch_scc1 L_p2special_17
    v_pk_mul_f32 v[152:153], v[136:137], v[40:41]
    v_pk_mul_f32 v[156:157], v[140:141], v[40:41]
    v_pk_fma_f32 v[152:153], v[140:141], v[48:49], v[152:153] neg_lo:[1,0,0] neg_hi:[1,0,0]
    v_pk_fma_f32 v[156:157], v[136:137], v[48:49], v[156:157]
    v_pk_mul_f32 v[154:155], v[138:139], v[42:43]
    v_pk_mul_f32 v[158:159], v[142:143], v[42:43]
    v_pk_fma_f32 v[154:155], v[142:143], v[50:51], v[154:155] neg_lo:[1,0,0] neg_hi:[1,0,0]
    v_pk_fma_f32 v[158:159], v[138:139], v[50:51], v[158:159]
    v_pk_mul_f32 v[160:161], v[144:145], v[44:45]
    v_pk_mul_f32 v[164:165], v[148:149], v[44:45]
    v_pk_fma_f32 v[160:161], v[148:149], v[52:53], v[160:161] neg_lo:[1,0,0] neg_hi:[1,0,0]
    v_pk_fma_f32 v[164:165], v[144:145], v[52:53], v[164:165]
    v_pk_mul_f32 v[162:163], v[146:147], v[46:47]
    v_pk_mul_f32 v[166:167], v[150:151], v[46:47]
    v_pk_fma_f32 v[162:163], v[150:151], v[54:55], v[162:163] neg_lo:[1,0,0] neg_hi:[1,0,0]
    v_pk_fma_f32 v[166:167], v[146:147], v[54:55], v[166:167]
L_p2join_16:
    v_cvt_pk_bf16_f32 v112, v152, v153
    v_cvt_pk_bf16_f32 v116, v156, v157
    v_cvt_pk_bf16_f32 v120, -v156, -v157
    v_cvt_pk_bf16_f32 v113, v154, v155
    v_cvt_pk_bf16_f32 v117, v158, v159
    v_cvt_pk_bf16_f32 v121, -v158, -v159
    v_cvt_pk_bf16_f32 v114, v160, v161
    v_cvt_pk_bf16_f32 v118, v164, v165
    v_cvt_pk_bf16_f32 v122, -v164, -v165
    v_cvt_pk_bf16_f32 v115, v162, v163
    v_cvt_pk_bf16_f32 v119, v166, v167
    v_cvt_pk_bf16_f32 v123, -v166, -v167
    v_mfma_f32_16x16x32_bf16 v[136:139], v[112:115], v[208:211], 0
    v_mfma_f32_16x16x32_bf16 v[140:143], v[116:119], v[208:211], 0
    v_mfma_f32_16x16x32_bf16 v[144:147], v[112:115], v[212:215], 0
    v_mfma_f32_16x16x32_bf16 v[148:151], v[116:119], v[212:215], 0
    v_mfma_f32_16x16x32_bf16 v[136:139], v[120:123], v[216:219], v[136:139]
    v_mfma_f32_16x16x32_bf16 v[140:143], v[112:115], v[216:219], v[140:143]
    v_mfma_f32_16x16x32_bf16 v[144:147], v[120:123], v[220:223], v[144:147]
    v_mfma_f32_16x16x32_bf16 v[148:151], v[112:115], v[220:223], v[148:151]
    s_lshr_b32 s66, s48, 1
    s_lshl_b32 s66, s66, 10
    s_and_b32 s67, s48, 1
    s_lshl_b32 s67, s67, 3
    s_add_u32 s66, s66, s67
    s_add_u32 s66, s66, 155648
    v_add_u32 v22, s66, v3
    v_add_u32 v23, 155648, v3
    v_cvt_pk_bf16_f32 v24, v136, v137
    v_cvt_pk_bf16_f32 v25, v138, v139
    ds_write_b64 v22, v[24:25] offset:0
    v_cvt_pk_bf16_f32 v26, v140, v141
    v_cvt_pk_bf16_f32 v27, v142, v143
    ds_write_b64 v22, v[26:27] offset:4096
    v_cvt_pk_bf16_f32 v28, v144, v145
    v_cvt_pk_bf16_f32 v29, v146, v147
    ds_write_b64 v22, v[28:29] offset:2048
    v_cvt_pk_bf16_f32 v30, v148, v149
    v_cvt_pk_bf16_f32 v31, v150, v151
    ds_write_b64 v22, v[30:31] offset:6144
    buffer_load_dwordx4 a[88:91], v4, s[8:11], s85 offen offset:2048 sc1
    buffer_load_dwordx4 a[92:95], v4, s[8:11], s85 offen offset:3072 sc1
    buffer_load_dwordx4 a[96:99], v4, s[8:11], s86 offen offset:0 sc1
    buffer_load_dwordx4 a[100:103], v4, s[8:11], s86 offen offset:1024 sc1
    buffer_load_dwordx4 a[104:107], v4, s[8:11], s86 offen offset:2048 sc1
    buffer_load_dwordx4 a[108:111], v4, s[8:11], s86 offen offset:3072 sc1
    s_waitcnt lgkmcnt(0)
    s_barrier
    ds_read_b128 v[112:115], v23 offset:0
    ds_read_b128 v[116:119], v23 offset:1024
    ds_read_b128 v[120:123], v23 offset:2048
    ds_read_b128 v[124:127], v23 offset:3072
    ds_read_b128 v[128:131], v23 offset:4096
    ds_read_b128 v[132:135], v23 offset:5120
    ds_read_b128 v[136:139], v23 offset:6144
    ds_read_b128 v[140:143], v23 offset:7168
    v_lshlrev_b32 v22, 4, v2
    v_lshl_add_u32 v22, v1, 17, v22
    s_lshl_b32 s66, s62, 15
    s_lshl_b32 s67, s48, 13
    s_add_u32 s66, s66, s67
    s_lshl_b32 s67, s61, 6
    s_add_u32 s66, s66, s67
    s_add_u32 s66, s66, 12582912
    s_add_u32 s67, s66, 2097152
    s_add_u32 s68, s66, 4096
    s_add_u32 s69, s67, 4096
    s_waitcnt lgkmcnt(0)
    v_xor_b32 v144, 0x80008000, v128
    v_xor_b32 v145, 0x80008000, v129
    v_xor_b32 v146, 0x80008000, v130
    v_xor_b32 v147, 0x80008000, v131
    v_xor_b32 v148, 0x80008000, v132
    v_xor_b32 v149, 0x80008000, v133
    v_xor_b32 v150, 0x80008000, v134
    v_xor_b32 v151, 0x80008000, v135
    v_xor_b32 v152, 0x80008000, v136
    v_xor_b32 v153, 0x80008000, v137
    v_xor_b32 v154, 0x80008000, v138
    v_xor_b32 v155, 0x80008000, v139
    v_xor_b32 v156, 0x80008000, v140
    v_xor_b32 v157, 0x80008000, v141
    v_xor_b32 v158, 0x80008000, v142
    v_xor_b32 v159, 0x80008000, v143
    v_mfma_f32_16x16x32_bf16 v[176:179], v[224:227], v[112:115], 0
    v_mfma_f32_16x16x32_bf16 v[180:183], v[224:227], v[128:131], 0
    v_mfma_f32_16x16x32_bf16 v[184:187], v[224:227], v[120:123], 0
    v_mfma_f32_16x16x32_bf16 v[188:191], v[224:227], v[136:139], 0
    v_mfma_f32_16x16x32_bf16 v[176:179], v[228:231], v[116:119], v[176:179]
    v_mfma_f32_16x16x32_bf16 v[180:183], v[228:231], v[132:135], v[180:183]
    v_mfma_f32_16x16x32_bf16 v[184:187], v[228:231], v[124:127], v[184:187]
    v_mfma_f32_16x16x32_bf16 v[188:191], v[228:231], v[140:143], v[188:191]
    v_mfma_f32_16x16x32_bf16 v[176:179], v[240:243], v[144:147], v[176:179]
    v_mfma_f32_16x16x32_bf16 v[180:183], v[240:243], v[112:115], v[180:183]
    v_mfma_f32_16x16x32_bf16 v[184:187], v[240:243], v[152:155], v[184:187]
    v_mfma_f32_16x16x32_bf16 v[188:191], v[240:243], v[120:123], v[188:191]
    v_mfma_f32_16x16x32_bf16 v[176:179], v[244:247], v[148:151], v[176:179]
    v_mfma_f32_16x16x32_bf16 v[180:183], v[244:247], v[116:119], v[180:183]
    v_mfma_f32_16x16x32_bf16 v[184:187], v[244:247], v[156:159], v[184:187]
    v_mfma_f32_16x16x32_bf16 v[188:191], v[244:247], v[124:127], v[188:191]
    v_mfma_f32_16x16x32_bf16 v[192:195], v[232:235], v[112:115], 0
    v_mfma_f32_16x16x32_bf16 v[196:199], v[232:235], v[128:131], 0
    v_mfma_f32_16x16x32_bf16 v[200:203], v[232:235], v[120:123], 0
    v_mfma_f32_16x16x32_bf16 v[204:207], v[232:235], v[136:139], 0
    v_mfma_f32_16x16x32_bf16 v[192:195], v[236:239], v[116:119], v[192:195]
    v_mfma_f32_16x16x32_bf16 v[196:199], v[236:239], v[132:135], v[196:199]
    v_mfma_f32_16x16x32_bf16 v[200:203], v[236:239], v[124:127], v[200:203]
    v_mfma_f32_16x16x32_bf16 v[204:207], v[236:239], v[140:143], v[204:207]
    v_mfma_f32_16x16x32_bf16 v[192:195], v[248:251], v[144:147], v[192:195]
    v_mfma_f32_16x16x32_bf16 v[196:199], v[248:251], v[112:115], v[196:199]
    v_mfma_f32_16x16x32_bf16 v[200:203], v[248:251], v[152:155], v[200:203]
    v_mfma_f32_16x16x32_bf16 v[204:207], v[248:251], v[120:123], v[204:207]
    v_mfma_f32_16x16x32_bf16 v[192:195], v[252:255], v[148:151], v[192:195]
    v_mfma_f32_16x16x32_bf16 v[196:199], v[252:255], v[116:119], v[196:199]
    v_mfma_f32_16x16x32_bf16 v[200:203], v[252:255], v[156:159], v[200:203]
    v_mfma_f32_16x16x32_bf16 v[204:207], v[252:255], v[124:127], v[204:207]
    s_and_b32 s79, s63, 30
    s_lshl_b32 s79, s79, 9
    s_add_u32 s79, s79, 17842176
    v_min_u32 v19, 63, v0
    v_lshlrev_b32 v19, 4, v19
    buffer_load_dword v20, v19, s[8:11], s79 offen sc1
    v_cvt_pk_bf16_f32 v24, v176, v177
    v_cvt_pk_bf16_f32 v25, v178, v179
    v_cvt_pk_bf16_f32 v26, v180, v181
    v_cvt_pk_bf16_f32 v27, v182, v183
    buffer_store_dwordx4 v[24:27], v22, s[8:11], s66 offen sc1
    v_cvt_pk_bf16_f32 v28, v184, v185
    v_cvt_pk_bf16_f32 v29, v186, v187
    v_cvt_pk_bf16_f32 v30, v188, v189
    v_cvt_pk_bf16_f32 v31, v190, v191
    buffer_store_dwordx4 v[28:31], v22, s[8:11], s67 offen sc1
    v_cvt_pk_bf16_f32 v32, v192, v193
    v_cvt_pk_bf16_f32 v33, v194, v195
    v_cvt_pk_bf16_f32 v34, v196, v197
    v_cvt_pk_bf16_f32 v35, v198, v199
    buffer_store_dwordx4 v[32:35], v22, s[8:11], s68 offen sc1
    v_cvt_pk_bf16_f32 v36, v200, v201
    v_cvt_pk_bf16_f32 v37, v202, v203
    v_cvt_pk_bf16_f32 v38, v204, v205
    v_cvt_pk_bf16_f32 v39, v206, v207
    buffer_store_dwordx4 v[36:39], v22, s[8:11], s69 offen sc1
    s_waitcnt vmcnt(4)
    v_cmp_ne_u32 vcc, s101, v20
    s_nop 1
    s_cbranch_vccnz L_poll_19
L_polled_20:
    buffer_load_dwordx4 a[112:115], v5, s[8:11], s80 offen sc1
    buffer_load_dwordx4 a[116:119], v6, s[8:11], s80 offen sc1
    buffer_load_dwordx4 a[120:123], v7, s[8:11], s80 offen sc1
    buffer_load_dwordx4 a[124:127], v8, s[8:11], s80 offen sc1
    v_lshlrev_b32 v24, 3, v2
    v_cvt_f32_u32 v24, v24
    v_lshl_add_u32 v22, v1, 1, 0
    v_cvt_f32_u32 v22, v22
    v_mul_f32 v22, 0x3c800000, v22
    v_mul_f32 v23, v24, v22
    v_cos_f32 v26, v23
    v_sin_f32 v27, v23
    v_add_f32 v34, v23, v22
    v_add_f32 v35, v22, v22
    v_cos_f32 v28, v34
    v_sin_f32 v29, v34
    v_cos_f32 v30, v35
    v_sin_f32 v31, v35
    v_cvt_pk_bf16_f32 v38, v26, v28
    v_cvt_pk_bf16_f32 v39, v27, v29
    v_accvgpr_write_b32 a224, v38
    v_accvgpr_write_b32 a228, v39
    v_xor_b32 v38, 0x80000000, v38
    v_xor_b32 v39, 0x80000000, v39
    v_accvgpr_write_b32 a232, v38
    v_accvgpr_write_b32 a236, v39
    v_pk_mul_f32 v[34:35], v[26:27], v[30:31] op_sel_hi:[1,0]
    v_pk_mul_f32 v[36:37], v[28:29], v[30:31] op_sel_hi:[1,0]
    v_pk_fma_f32 v[26:27], v[26:27], v[30:31], v[34:35] op_sel:[1,1,0] op_sel_hi:[0,1,1] neg_lo:[1,0,0]
    v_pk_fma_f32 v[28:29], v[28:29], v[30:31], v[36:37] op_sel:[1,1,0] op_sel_hi:[0,1,1] neg_lo:[1,0,0]
    v_cvt_pk_bf16_f32 v38, v26, v28
    v_cvt_pk_bf16_f32 v39, v27, v29
    v_accvgpr_write_b32 a225, v38
    v_accvgpr_write_b32 a229, v39
    v_xor_b32 v38, 0x80000000, v38
    v_xor_b32 v39, 0x80000000, v39
    v_accvgpr_write_b32 a233, v38
    v_accvgpr_write_b32 a237, v39
    v_pk_mul_f32 v[34:35], v[26:27], v[30:31] op_sel_hi:[1,0]
    v_pk_mul_f32 v[36:37], v[28:29], v[30:31] op_sel_hi:[1,0]
    v_pk_fma_f32 v[26:27], v[26:27], v[30:31], v[34:35] op_sel:[1,1,0] op_sel_hi:[0,1,1] neg_lo:[1,0,0]
    v_pk_fma_f32 v[28:29], v[28:29], v[30:31], v[36:37] op_sel:[1,1,0] op_sel_hi:[0,1,1] neg_lo:[1,0,0]
    v_cvt_pk_bf16_f32 v38, v26, v28
    v_cvt_pk_bf16_f32 v39, v27, v29
    v_accvgpr_write_b32 a226, v38
    v_accvgpr_write_b32 a230, v39
    v_xor_b32 v38, 0x80000000, v38
    v_xor_b32 v39, 0x80000000, v39
    v_accvgpr_write_b32 a234, v38
    v_accvgpr_write_b32 a238, v39
    v_pk_mul_f32 v[34:35], v[26:27], v[30:31] op_sel_hi:[1,0]
    v_pk_mul_f32 v[36:37], v[28:29], v[30:31] op_sel_hi:[1,0]
    v_pk_fma_f32 v[26:27], v[26:27], v[30:31], v[34:35] op_sel:[1,1,0] op_sel_hi:[0,1,1] neg_lo:[1,0,0]
    v_pk_fma_f32 v[28:29], v[28:29], v[30:31], v[36:37] op_sel:[1,1,0] op_sel_hi:[0,1,1] neg_lo:[1,0,0]
    v_cvt_pk_bf16_f32 v38, v26, v28
    v_cvt_pk_bf16_f32 v39, v27, v29
    v_accvgpr_write_b32 a227, v38
    v_accvgpr_write_b32 a231, v39
    v_xor_b32 v38, 0x80000000, v38
    v_xor_b32 v39, 0x80000000, v39
    v_accvgpr_write_b32 a235, v38
    v_accvgpr_write_b32 a239, v39
    v_lshl_add_u32 v22, v1, 1, 1
    v_cvt_f32_u32 v22, v22
    v_mul_f32 v22, 0x3c800000, v22
    v_mul_f32 v23, v24, v22
    v_cos_f32 v26, v23
    v_sin_f32 v27, v23
    v_add_f32 v34, v23, v22
    v_add_f32 v35, v22, v22
    v_cos_f32 v28, v34
    v_sin_f32 v29, v34
    v_cos_f32 v30, v35
    v_sin_f32 v31, v35
    v_cvt_pk_bf16_f32 v38, v26, v28
    v_cvt_pk_bf16_f32 v39, v27, v29
    v_accvgpr_write_b32 a240, v38
    v_accvgpr_write_b32 a244, v39
    v_xor_b32 v38, 0x80000000, v38
    v_xor_b32 v39, 0x80000000, v39
    v_accvgpr_write_b32 a248, v38
    v_accvgpr_write_b32 a252, v39
    v_pk_mul_f32 v[34:35], v[26:27], v[30:31] op_sel_hi:[1,0]
    v_pk_mul_f32 v[36:37], v[28:29], v[30:31] op_sel_hi:[1,0]
    v_pk_fma_f32 v[26:27], v[26:27], v[30:31], v[34:35] op_sel:[1,1,0] op_sel_hi:[0,1,1] neg_lo:[1,0,0]
    v_pk_fma_f32 v[28:29], v[28:29], v[30:31], v[36:37] op_sel:[1,1,0] op_sel_hi:[0,1,1] neg_lo:[1,0,0]
    v_cvt_pk_bf16_f32 v38, v26, v28
    v_cvt_pk_bf16_f32 v39, v27, v29
    v_accvgpr_write_b32 a241, v38
    v_accvgpr_write_b32 a245, v39
    v_xor_b32 v38, 0x80000000, v38
    v_xor_b32 v39, 0x80000000, v39
    v_accvgpr_write_b32 a249, v38
    v_accvgpr_write_b32 a253, v39
    v_pk_mul_f32 v[34:35], v[26:27], v[30:31] op_sel_hi:[1,0]
    v_pk_mul_f32 v[36:37], v[28:29], v[30:31] op_sel_hi:[1,0]
    v_pk_fma_f32 v[26:27], v[26:27], v[30:31], v[34:35] op_sel:[1,1,0] op_sel_hi:[0,1,1] neg_lo:[1,0,0]
    v_pk_fma_f32 v[28:29], v[28:29], v[30:31], v[36:37] op_sel:[1,1,0] op_sel_hi:[0,1,1] neg_lo:[1,0,0]
    v_cvt_pk_bf16_f32 v38, v26, v28
    v_cvt_pk_bf16_f32 v39, v27, v29
    v_accvgpr_write_b32 a242, v38
    v_accvgpr_write_b32 a246, v39
    v_xor_b32 v38, 0x80000000, v38
    v_xor_b32 v39, 0x80000000, v39
    v_accvgpr_write_b32 a250, v38
    v_accvgpr_write_b32 a254, v39
    v_pk_mul_f32 v[34:35], v[26:27], v[30:31] op_sel_hi:[1,0]
    v_pk_mul_f32 v[36:37], v[28:29], v[30:31] op_sel_hi:[1,0]
    v_pk_fma_f32 v[26:27], v[26:27], v[30:31], v[34:35] op_sel:[1,1,0] op_sel_hi:[0,1,1] neg_lo:[1,0,0]
    v_pk_fma_f32 v[28:29], v[28:29], v[30:31], v[36:37] op_sel:[1,1,0] op_sel_hi:[0,1,1] neg_lo:[1,0,0]
    v_cvt_pk_bf16_f32 v38, v26, v28
    v_cvt_pk_bf16_f32 v39, v27, v29
    v_accvgpr_write_b32 a243, v38
    v_accvgpr_write_b32 a247, v39
    v_xor_b32 v38, 0x80000000, v38
    v_xor_b32 v39, 0x80000000, v39
    v_accvgpr_write_b32 a251, v38
    v_accvgpr_write_b32 a255, v39
    v_lshlrev_b32 v220, 2, v2
    v_sub_u32 v220, v1, v220
    v_mov_b32 v221, 0x3f80
    v_mov_b32 v222, 0x3f800000
    v_cmp_eq_u32 vcc, 0, v220
    s_nop 1
    v_cndmask_b32 v216, 0, v221, vcc
    v_cmp_eq_u32 vcc, 1, v220
    s_nop 1
    v_cndmask_b32 v216, v216, v222, vcc
    v_mov_b32 v218, v216
    v_cmp_eq_u32 vcc, 2, v220
    s_nop 1
    v_cndmask_b32 v217, 0, v221, vcc
    v_cmp_eq_u32 vcc, 3, v220
    s_nop 1
    v_cndmask_b32 v217, v217, v222, vcc
    v_mov_b32 v219, v217
    v_mov_b32 v190, 0
    v_mov_b32 v191, 0
    v_mov_b32 v198, 0
    v_mov_b32 v199, 0
    v_mov_b32 v206, 0
    v_mov_b32 v207, 0
    v_mov_b32 v214, 0
    v_mov_b32 v215, 0
    s_lshl_b32 s66, s62, 12
    s_lshl_b32 s67, s48, 10
    s_add_u32 s66, s66, s67
    s_lshl_b32 s67, s61, 4
    s_add_u32 s66, s66, s67
    s_add_u32 s66, s66, 17858560
    s_waitcnt vmcnt(4)
    s_mov_b32 s3, s101
    s_atomic_swap s3, s[8:9], s66 glc
    buffer_load_dwordx4 a[128:131], v5, s[8:11], s81 offen sc1
    buffer_load_dwordx4 a[132:135], v6, s[8:11], s81 offen sc1
    buffer_load_dwordx4 a[136:139], v7, s[8:11], s81 offen sc1
    buffer_load_dwordx4 a[140:143], v8, s[8:11], s81 offen sc1
    buffer_load_dwordx4 a[144:147], v5, s[8:11], s82 offen sc1
    buffer_load_dwordx4 a[148:151], v6, s[8:11], s82 offen sc1
    buffer_load_dwordx4 a[152:155], v7, s[8:11], s82 offen sc1
    buffer_load_dwordx4 a[156:159], v8, s[8:11], s82 offen sc1
    s_lshl_b32 s66, s64, 5
    v_lshlrev_b32 v16, 3, v2
    buffer_load_dwordx2 v[22:23], v16, s[32:35], s66 offen offset:0
    buffer_load_dwordx2 v[24:25], v16, s[32:35], s66 offen offset:256
    buffer_load_dwordx2 v[26:27], v16, s[32:35], s66 offen offset:512
    buffer_load_dwordx2 v[28:29], v16, s[32:35], s66 offen offset:768
    s_xor_b32 s74, s48, 1
    s_mul_i32 s74, s74, 12288
    s_add_u32 s74, s74, 0
    v_add_u32 v11, s74, v3
    s_xor_b32 s74, s48, 2
    s_mul_i32 s74, s74, 12288
    s_add_u32 s74, s74, 8
    v_add_u32 v12, s74, v3
    s_xor_b32 s74, s48, 3
    s_mul_i32 s74, s74, 12288
    s_add_u32 s74, s74, 4096
    v_add_u32 v13, s74, v3
    s_mul_i32 s74, s48, 12288
    s_add_u32 s74, s74, 0
    v_add_u32 v10, s74, v3
    s_and_b32 s74, s48, 1
    s_lshl_b32 s74, s74, 5
    s_lshr_b32 s75, s48, 1
    s_add_u32 s74, s74, s75
    s_lshl_b32 s74, s74, 5
    s_add_u32 s74, s74, s63
    s_lshl_b32 s74, s74, 10
    s_lshl_b32 s75, s64, 5
    s_add_u32 s99, s74, s75
    v_and_b32 v14, 1, v2
    v_lshlrev_b32 v14, 8, v14
    v_lshl_add_u32 v14, v1, 16, v14
    v_lshrrev_b32 v16, 1, v2
    v_lshl_add_u32 v14, v16, 4, v14
    s_lshl_b32 s74, s48, 13
    s_sub_u32 s74, 147456, s74
    v_add_u32 v21, s74, v21
    s_lshl_b32 s66, s63, 2
    s_add_u32 s66, s66, s48
    s_lshl_b32 s66, s66, 6
    s_add_u32 s66, s66, 16777216
    v_lshlrev_b32 v16, 2, v1
    buffer_load_dword v250, v16, s[8:11], s66 offen sc1
    s_waitcnt vmcnt(16)
    v_mfma_f32_16x16x32_bf16 v[56:59], a[0:3], a[112:115], 0
    v_mfma_f32_16x16x32_bf16 v[72:75], a[4:7], a[112:115], 0
    v_mfma_f32_16x16x32_bf16 v[88:91], a[8:11], a[112:115], 0
    v_mfma_f32_16x16x32_bf16 v[104:107], a[12:15], a[112:115], 0
    buffer_load_dwordx4 a[160:163], v5, s[8:11], s83 offen sc1
    s_waitcnt vmcnt(16)
    v_mfma_f32_16x16x32_bf16 v[60:63], a[0:3], a[116:119], 0
    v_mfma_f32_16x16x32_bf16 v[76:79], a[4:7], a[116:119], 0
    v_mfma_f32_16x16x32_bf16 v[92:95], a[8:11], a[116:119], 0
    v_mfma_f32_16x16x32_bf16 v[108:111], a[12:15], a[116:119], 0
    buffer_load_dwordx4 a[164:167], v6, s[8:11], s83 offen sc1
    s_waitcnt vmcnt(16)
    v_mfma_f32_16x16x32_bf16 v[64:67], a[0:3], a[120:123], 0
    v_mfma_f32_16x16x32_bf16 v[80:83], a[4:7], a[120:123], 0
    v_mfma_f32_16x16x32_bf16 v[96:99], a[8:11], a[120:123], 0
    v_mfma_f32_16x16x32_bf16 v[112:115], a[12:15], a[120:123], 0
    buffer_load_dwordx4 a[168:171], v7, s[8:11], s83 offen sc1
    s_waitcnt vmcnt(16)
    v_mfma_f32_16x16x32_bf16 v[68:71], a[0:3], a[124:127], 0
    v_mfma_f32_16x16x32_bf16 v[84:87], a[4:7], a[124:127], 0
    v_mfma_f32_16x16x32_bf16 v[100:103], a[8:11], a[124:127], 0
    v_mfma_f32_16x16x32_bf16 v[116:119], a[12:15], a[124:127], 0
    buffer_load_dwordx4 a[172:175], v8, s[8:11], s83 offen sc1
    s_waitcnt vmcnt(16)
    v_mfma_f32_16x16x32_bf16 v[56:59], a[16:19], a[128:131], v[56:59]
    v_mfma_f32_16x16x32_bf16 v[72:75], a[20:23], a[128:131], v[72:75]
    v_mfma_f32_16x16x32_bf16 v[88:91], a[24:27], a[128:131], v[88:91]
    v_mfma_f32_16x16x32_bf16 v[104:107], a[28:31], a[128:131], v[104:107]
    buffer_load_dwordx4 a[176:179], v5, s[8:11], s84 offen sc1
    s_waitcnt vmcnt(16)
    v_mfma_f32_16x16x32_bf16 v[60:63], a[16:19], a[132:135], v[60:63]
    v_mfma_f32_16x16x32_bf16 v[76:79], a[20:23], a[132:135], v[76:79]
    v_mfma_f32_16x16x32_bf16 v[92:95], a[24:27], a[132:135], v[92:95]
    v_mfma_f32_16x16x32_bf16 v[108:111], a[28:31], a[132:135], v[108:111]
    buffer_load_dwordx4 a[180:183], v6, s[8:11], s84 offen sc1
    s_waitcnt vmcnt(16)
    v_mfma_f32_16x16x32_bf16 v[64:67], a[16:19], a[136:139], v[64:67]
    v_mfma_f32_16x16x32_bf16 v[80:83], a[20:23], a[136:139], v[80:83]
    v_mfma_f32_16x16x32_bf16 v[96:99], a[24:27], a[136:139], v[96:99]
    v_mfma_f32_16x16x32_bf16 v[112:115], a[28:31], a[136:139], v[112:115]
    buffer_load_dwordx4 a[184:187], v7, s[8:11], s84 offen sc1
    s_waitcnt vmcnt(16)
    v_mfma_f32_16x16x32_bf16 v[68:71], a[16:19], a[140:143], v[68:71]
    v_mfma_f32_16x16x32_bf16 v[84:87], a[20:23], a[140:143], v[84:87]
    v_mfma_f32_16x16x32_bf16 v[100:103], a[24:27], a[140:143], v[100:103]
    v_mfma_f32_16x16x32_bf16 v[116:119], a[28:31], a[140:143], v[116:119]
    buffer_load_dwordx4 a[188:191], v8, s[8:11], s84 offen sc1
    s_waitcnt vmcnt(16)
    v_mfma_f32_16x16x32_bf16 v[56:59], a[32:35], a[144:147], v[56:59]
    v_mfma_f32_16x16x32_bf16 v[72:75], a[36:39], a[144:147], v[72:75]
    v_mfma_f32_16x16x32_bf16 v[88:91], a[40:43], a[144:147], v[88:91]
    v_mfma_f32_16x16x32_bf16 v[104:107], a[44:47], a[144:147], v[104:107]
    buffer_load_dwordx4 a[192:195], v5, s[8:11], s85 offen sc1
    s_waitcnt vmcnt(16)
    v_mfma_f32_16x16x32_bf16 v[60:63], a[32:35], a[148:151], v[60:63]
    v_mfma_f32_16x16x32_bf16 v[76:79], a[36:39], a[148:151], v[76:79]
    v_mfma_f32_16x16x32_bf16 v[92:95], a[40:43], a[148:151], v[92:95]
    v_mfma_f32_16x16x32_bf16 v[108:111], a[44:47], a[148:151], v[108:111]
    buffer_load_dwordx4 a[196:199], v6, s[8:11], s85 offen sc1
    s_waitcnt vmcnt(16)
    v_mfma_f32_16x16x32_bf16 v[64:67], a[32:35], a[152:155], v[64:67]
    v_mfma_f32_16x16x32_bf16 v[80:83], a[36:39], a[152:155], v[80:83]
    v_mfma_f32_16x16x32_bf16 v[96:99], a[40:43], a[152:155], v[96:99]
    v_mfma_f32_16x16x32_bf16 v[112:115], a[44:47], a[152:155], v[112:115]
    buffer_load_dwordx4 a[200:203], v7, s[8:11], s85 offen sc1
    s_waitcnt vmcnt(16)
    v_mfma_f32_16x16x32_bf16 v[68:71], a[32:35], a[156:159], v[68:71]
    v_mfma_f32_16x16x32_bf16 v[84:87], a[36:39], a[156:159], v[84:87]
    v_mfma_f32_16x16x32_bf16 v[100:103], a[40:43], a[156:159], v[100:103]
    v_mfma_f32_16x16x32_bf16 v[116:119], a[44:47], a[156:159], v[116:119]
    buffer_load_dwordx4 a[204:207], v8, s[8:11], s85 offen sc1
    s_waitcnt vmcnt(11)
    v_mfma_f32_16x16x32_bf16 v[56:59], a[48:51], a[160:163], v[56:59]
    v_sub_f32 v248, 1.0, v250
    v_mfma_f32_16x16x32_bf16 v[72:75], a[52:55], a[160:163], v[72:75]
    v_cvt_pk_bf16_f32 v248, v248, v248
    v_mfma_f32_16x16x32_bf16 v[88:91], a[56:59], a[160:163], v[88:91]
    v_mul_f32 v54, 0x36000000, v250
    v_mfma_f32_16x16x32_bf16 v[104:107], a[60:63], a[160:163], v[104:107]
    v_and_b32 v248, 0xffff0000, v248
    buffer_load_dwordx4 a[208:211], v5, s[8:11], s86 offen sc1
    s_waitcnt vmcnt(11)
    v_mfma_f32_16x16x32_bf16 v[60:63], a[48:51], a[164:167], v[60:63]
    v_mov_b32 v55, v54
    v_mfma_f32_16x16x32_bf16 v[76:79], a[52:55], a[164:167], v[76:79]
    v_mov_b32 v249, v248
    v_mfma_f32_16x16x32_bf16 v[92:95], a[56:59], a[164:167], v[92:95]
    v_lshlrev_b32 v232, 16, v22
    v_mfma_f32_16x16x32_bf16 v[108:111], a[60:63], a[164:167], v[108:111]
    v_and_b32 v233, 0xffff0000, v22
    buffer_load_dwordx4 a[212:215], v6, s[8:11], s86 offen sc1
    s_waitcnt vmcnt(11)
    v_mfma_f32_16x16x32_bf16 v[64:67], a[48:51], a[168:171], v[64:67]
    v_lshlrev_b32 v234, 16, v23
    v_mfma_f32_16x16x32_bf16 v[80:83], a[52:55], a[168:171], v[80:83]
    v_and_b32 v235, 0xffff0000, v23
    v_mfma_f32_16x16x32_bf16 v[96:99], a[56:59], a[168:171], v[96:99]
    v_lshlrev_b32 v236, 16, v24
    v_mfma_f32_16x16x32_bf16 v[112:115], a[60:63], a[168:171], v[112:115]
    v_and_b32 v237, 0xffff0000, v24
    buffer_load_dwordx4 a[216:219], v7, s[8:11], s86 offen sc1
    s_waitcnt vmcnt(11)
    v_mfma_f32_16x16x32_bf16 v[68:71], a[48:51], a[172:175], v[68:71]
    v_lshlrev_b32 v238, 16, v25
    v_mfma_f32_16x16x32_bf16 v[84:87], a[52:55], a[172:175], v[84:87]
    v_and_b32 v239, 0xffff0000, v25
    v_mfma_f32_16x16x32_bf16 v[100:103], a[56:59], a[172:175], v[100:103]
    v_lshlrev_b32 v240, 16, v26
    v_mfma_f32_16x16x32_bf16 v[116:119], a[60:63], a[172:175], v[116:119]
    v_and_b32 v241, 0xffff0000, v26
    buffer_load_dwordx4 a[220:223], v8, s[8:11], s86 offen sc1
    s_waitcnt vmcnt(11)
    v_mfma_f32_16x16x32_bf16 v[56:59], a[64:67], a[176:179], v[56:59]
    v_lshlrev_b32 v242, 16, v27
    v_mfma_f32_16x16x32_bf16 v[72:75], a[68:71], a[176:179], v[72:75]
    v_and_b32 v243, 0xffff0000, v27
    v_mfma_f32_16x16x32_bf16 v[88:91], a[72:75], a[176:179], v[88:91]
    v_lshlrev_b32 v244, 16, v28
    v_mfma_f32_16x16x32_bf16 v[104:107], a[76:79], a[176:179], v[104:107]
    v_and_b32 v245, 0xffff0000, v28
    buffer_load_dwordx4 a[112:115], v5, s[8:11], s87 offen sc1
    s_waitcnt vmcnt(11)
    v_mfma_f32_16x16x32_bf16 v[60:63], a[64:67], a[180:183], v[60:63]
    v_lshlrev_b32 v246, 16, v29
    v_mfma_f32_16x16x32_bf16 v[76:79], a[68:71], a[180:183], v[76:79]
    v_and_b32 v247, 0xffff0000, v29
    v_mfma_f32_16x16x32_bf16 v[92:95], a[72:75], a[180:183], v[92:95]
    v_mul_f32 v232, v232, v248
    v_mfma_f32_16x16x32_bf16 v[108:111], a[76:79], a[180:183], v[108:111]
    v_mul_f32 v233, v233, v248
    buffer_load_dwordx4 a[116:119], v6, s[8:11], s87 offen sc1
    s_waitcnt vmcnt(11)
    v_mfma_f32_16x16x32_bf16 v[64:67], a[64:67], a[184:187], v[64:67]
    v_mul_f32 v234, v234, v248
    v_mfma_f32_16x16x32_bf16 v[80:83], a[68:71], a[184:187], v[80:83]
    v_mul_f32 v235, v235, v248
    v_mfma_f32_16x16x32_bf16 v[96:99], a[72:75], a[184:187], v[96:99]
    v_mul_f32 v236, v236, v248
    v_mfma_f32_16x16x32_bf16 v[112:115], a[76:79], a[184:187], v[112:115]
    v_mul_f32 v237, v237, v248
    buffer_load_dwordx4 a[120:123], v7, s[8:11], s87 offen sc1
    s_waitcnt vmcnt(11)
    v_mfma_f32_16x16x32_bf16 v[68:71], a[64:67], a[188:191], v[68:71]
    v_mul_f32 v238, v238, v248
    v_mfma_f32_16x16x32_bf16 v[84:87], a[68:71], a[188:191], v[84:87]
    v_mul_f32 v239, v239, v248
    v_mfma_f32_16x16x32_bf16 v[100:103], a[72:75], a[188:191], v[100:103]
    v_mul_f32 v240, v240, v248
    v_mfma_f32_16x16x32_bf16 v[116:119], a[76:79], a[188:191], v[116:119]
    v_mul_f32 v241, v241, v248
    buffer_load_dwordx4 a[124:127], v8, s[8:11], s87 offen sc1
    s_waitcnt vmcnt(11)
    v_mfma_f32_16x16x32_bf16 v[56:59], a[80:83], a[192:195], v[56:59]
    v_mul_f32 v242, v242, v248
    v_mfma_f32_16x16x32_bf16 v[72:75], a[84:87], a[192:195], v[72:75]
    v_mul_f32 v243, v243, v248
    v_mfma_f32_16x16x32_bf16 v[88:91], a[88:91], a[192:195], v[88:91]
    v_mul_f32 v244, v244, v248
    v_mfma_f32_16x16x32_bf16 v[104:107], a[92:95], a[192:195], v[104:107]
    v_mul_f32 v245, v245, v248
    buffer_load_dwordx4 a[128:131], v5, s[8:11], s88 offen sc1
    s_waitcnt vmcnt(11)
    v_mfma_f32_16x16x32_bf16 v[60:63], a[80:83], a[196:199], v[60:63]
    v_mul_f32 v246, v246, v248
    v_mfma_f32_16x16x32_bf16 v[76:79], a[84:87], a[196:199], v[76:79]
    v_mul_f32 v247, v247, v248
    v_mfma_f32_16x16x32_bf16 v[92:95], a[88:91], a[196:199], v[92:95]
    s_lshl_b32 s74, s48, 11
    v_mfma_f32_16x16x32_bf16 v[108:111], a[92:95], a[196:199], v[108:111]
    s_add_u32 s74, s74, 98304
    buffer_load_dwordx4 a[132:135], v6, s[8:11], s88 offen sc1
    s_waitcnt vmcnt(11)
    v_mfma_f32_16x16x32_bf16 v[64:67], a[80:83], a[200:203], v[64:67]
    v_add_u32 v15, s74, v3
    v_mfma_f32_16x16x32_bf16 v[80:83], a[84:87], a[200:203], v[80:83]
    v_mfma_f32_16x16x32_bf16 v[96:99], a[88:91], a[200:203], v[96:99]
    v_mfma_f32_16x16x32_bf16 v[112:115], a[92:95], a[200:203], v[112:115]
    buffer_load_dwordx4 a[136:139], v7, s[8:11], s88 offen sc1
    s_waitcnt vmcnt(11)
    v_mfma_f32_16x16x32_bf16 v[68:71], a[80:83], a[204:207], v[68:71]
    v_mfma_f32_16x16x32_bf16 v[84:87], a[84:87], a[204:207], v[84:87]
    v_mfma_f32_16x16x32_bf16 v[100:103], a[88:91], a[204:207], v[100:103]
    v_mfma_f32_16x16x32_bf16 v[116:119], a[92:95], a[204:207], v[116:119]
    buffer_load_dwordx4 a[140:143], v8, s[8:11], s88 offen sc1
    s_lshr_b32 s68, s64, 1
    s_lshl_b32 s66, s48, 12
    s_lshl_b32 s67, s68, 10
    s_add_u32 s66, s66, s67
    s_add_u32 s66, s66, 17858560
    s_mov_b32 s78, s66
    v_min_u32 v17, 63, v0
    v_lshlrev_b32 v17, 4, v17
    buffer_load_dword v18, v17, s[8:11], s78 offen sc1
    s_waitcnt vmcnt(11)
    v_mfma_f32_16x16x32_bf16 v[60:63], a[96:99], a[212:215], v[60:63]
    v_mfma_f32_16x16x32_bf16 v[76:79], a[100:103], a[212:215], v[76:79]
    v_mfma_f32_16x16x32_bf16 v[92:95], a[104:107], a[212:215], v[92:95]
    v_mfma_f32_16x16x32_bf16 v[108:111], a[108:111], a[212:215], v[108:111]
    buffer_load_dwordx4 a[148:151], v6, s[8:11], s89 offen sc1
    s_waitcnt vmcnt(11)
    v_mfma_f32_16x16x32_bf16 v[64:67], a[96:99], a[216:219], v[64:67]
    s_nop 1
    v_cvt_pk_bf16_f32 v220, v60, v61
    v_cvt_pk_bf16_f32 v221, v62, v63
    ds_write_b64 v11, v[220:221] offset:0
    v_mfma_f32_16x16x32_bf16 v[80:83], a[100:103], a[216:219], v[80:83]
    v_cvt_pk_bf16_f32 v222, v76, v77
    v_cvt_pk_bf16_f32 v223, v78, v79
    ds_write_b64 v11, v[222:223] offset:1024
    v_mfma_f32_16x16x32_bf16 v[96:99], a[104:107], a[216:219], v[96:99]
    v_cvt_pk_bf16_f32 v220, v92, v93
    v_cvt_pk_bf16_f32 v221, v94, v95
    ds_write_b64 v11, v[220:221] offset:2048
    v_mfma_f32_16x16x32_bf16 v[112:115], a[108:111], a[216:219], v[112:115]
    v_cvt_pk_bf16_f32 v222, v108, v109
    v_cvt_pk_bf16_f32 v223, v110, v111
    ds_write_b64 v11, v[222:223] offset:3072
    buffer_load_dwordx4 a[152:155], v7, s[8:11], s89 offen sc1
    s_waitcnt vmcnt(11)
    v_mfma_f32_16x16x32_bf16 v[68:71], a[96:99], a[220:223], v[68:71]
    v_cvt_pk_bf16_f32 v220, v64, v65
    v_cvt_pk_bf16_f32 v221, v66, v67
    ds_write_b64 v12, v[220:221] offset:0
    v_mfma_f32_16x16x32_bf16 v[84:87], a[100:103], a[220:223], v[84:87]
    v_cvt_pk_bf16_f32 v222, v80, v81
    v_cvt_pk_bf16_f32 v223, v82, v83
    ds_write_b64 v12, v[222:223] offset:1024
    v_mfma_f32_16x16x32_bf16 v[100:103], a[104:107], a[220:223], v[100:103]
    v_cvt_pk_bf16_f32 v220, v96, v97
    v_cvt_pk_bf16_f32 v221, v98, v99
    ds_write_b64 v12, v[220:221] offset:2048
    v_mfma_f32_16x16x32_bf16 v[116:119], a[108:111], a[220:223], v[116:119]
    v_cvt_pk_bf16_f32 v222, v112, v113
    v_cvt_pk_bf16_f32 v223, v114, v115
    ds_write_b64 v12, v[222:223] offset:3072
    buffer_load_dwordx4 a[156:159], v8, s[8:11], s89 offen sc1
    v_mfma_f32_16x16x32_bf16 v[56:59], a[96:99], a[208:211], v[56:59]
    v_cvt_pk_bf16_f32 v220, v68, v69
    v_cvt_pk_bf16_f32 v221, v70, v71
    ds_write_b64 v13, v[220:221] offset:0
    v_mfma_f32_16x16x32_bf16 v[72:75], a[100:103], a[208:211], v[72:75]
    v_cvt_pk_bf16_f32 v222, v84, v85
    v_cvt_pk_bf16_f32 v223, v86, v87
    ds_write_b64 v13, v[222:223] offset:1024
    v_mfma_f32_16x16x32_bf16 v[88:91], a[104:107], a[208:211], v[88:91]
    v_cvt_pk_bf16_f32 v220, v100, v101
    v_cvt_pk_bf16_f32 v221, v102, v103
    ds_write_b64 v13, v[220:221] offset:2048
    v_mfma_f32_16x16x32_bf16 v[104:107], a[108:111], a[208:211], v[104:107]
    v_cvt_pk_bf16_f32 v222, v116, v117
    v_cvt_pk_bf16_f32 v223, v118, v119
    ds_write_b64 v13, v[222:223] offset:3072
    buffer_load_dwordx4 a[144:147], v5, s[8:11], s89 offen sc1
    s_waitcnt lgkmcnt(0)
    s_barrier
    ds_read_b128 v[184:187], v10 offset:0
    ds_read_b64 v[188:189], v10 offset:4096
    ds_read_b128 v[192:195], v10 offset:1024
    ds_read_b64 v[196:197], v10 offset:5120
    ds_read_b128 v[200:203], v10 offset:2048
    ds_read_b64 v[204:205], v10 offset:6144
    ds_read_b128 v[208:211], v10 offset:3072
    ds_read_b64 v[212:213], v10 offset:7168
    s_waitcnt vmcnt(4)
    v_cmp_ne_u32 vcc, s101, v18
    s_nop 1
    s_cbranch_vccnz L_poll_22
L_polled_23:
    s_lshl2_add_u32 s66, s63, s48
    s_lshl3_add_u32 s66, s66, s64
    s_lshl_b32 s66, s66, 12
    s_add_u32 s66, s66, 12582912
    s_lshl_b32 s67, s48, 12
    s_add_u32 m0, s67, 147456
    s_nop 0
    buffer_load_dwordx4 v3, s[8:11], s66 offen offset:0 sc1 lds
    buffer_load_dwordx4 v3, s[8:11], s66 offen offset:1024 sc1 lds
    buffer_load_dwordx4 v3, s[8:11], s66 offen offset:2048 sc1 lds
    buffer_load_dwordx4 v3, s[8:11], s66 offen offset:3072 sc1 lds
    s_waitcnt lgkmcnt(6)
    v_mfma_f32_16x16x32_bf16 v[56:59], v[216:219], v[184:187], v[56:59]
    s_waitcnt lgkmcnt(4)
    v_mfma_f32_16x16x32_bf16 v[72:75], v[216:219], v[192:195], v[72:75]
    s_waitcnt lgkmcnt(2)
    v_mfma_f32_16x16x32_bf16 v[88:91], v[216:219], v[200:203], v[88:91]
    s_waitcnt lgkmcnt(0)
    v_mfma_f32_16x16x32_bf16 v[104:107], v[216:219], v[208:211], v[104:107]
    v_mfma_f32_16x16x32_bf16 v[56:59], v[216:219], v[188:191], v[56:59]
    v_mfma_f32_16x16x32_bf16 v[72:75], v[216:219], v[196:199], v[72:75]
    v_mfma_f32_16x16x32_bf16 v[88:91], v[216:219], v[204:207], v[88:91]
    v_mfma_f32_16x16x32_bf16 v[104:107], v[216:219], v[212:215], v[104:107]
    s_mov_b32 s66, s2
    s_lshl2_add_u32 s66, s66, s48
    s_lshl_b32 s66, s66, 11
    s_add_u32 s66, s66, 18874368
    s_nop 0
    v_cvt_pk_bf16_f32 v22, v56, v57
    v_cvt_pk_bf16_f32 v23, v58, v59
    v_cvt_pk_bf16_f32 v24, v72, v73
    v_cvt_pk_bf16_f32 v25, v74, v75
    buffer_store_dwordx4 v[22:25], v3, s[8:11], s66 offen offset:0 sc1
    v_cvt_pk_bf16_f32 v26, v88, v89
    v_cvt_pk_bf16_f32 v27, v90, v91
    v_cvt_pk_bf16_f32 v28, v104, v105
    v_cvt_pk_bf16_f32 v29, v106, v107
    buffer_store_dwordx4 v[26:29], v3, s[8:11], s66 offen offset:1024 sc1
    v_mfma_f32_16x16x32_bf16 v[120:123], a[0:3], a[112:115], 0
    v_mfma_f32_16x16x32_bf16 v[136:139], a[4:7], a[112:115], 0
    v_mfma_f32_16x16x32_bf16 v[152:155], a[8:11], a[112:115], 0
    v_mfma_f32_16x16x32_bf16 v[168:171], a[12:15], a[112:115], 0
    buffer_load_dwordx4 a[160:163], v5, s[8:11], s90 offen sc1
    v_mfma_f32_16x16x32_bf16 v[124:127], a[0:3], a[116:119], 0
    v_mfma_f32_16x16x32_bf16 v[140:143], a[4:7], a[116:119], 0
    v_mfma_f32_16x16x32_bf16 v[156:159], a[8:11], a[116:119], 0
    v_mfma_f32_16x16x32_bf16 v[172:175], a[12:15], a[116:119], 0
    buffer_load_dwordx4 a[164:167], v6, s[8:11], s90 offen sc1
    v_mfma_f32_16x16x32_bf16 v[128:131], a[0:3], a[120:123], 0
    v_mfma_f32_16x16x32_bf16 v[144:147], a[4:7], a[120:123], 0
    v_mfma_f32_16x16x32_bf16 v[160:163], a[8:11], a[120:123], 0
    v_mfma_f32_16x16x32_bf16 v[176:179], a[12:15], a[120:123], 0
    buffer_load_dwordx4 a[168:171], v7, s[8:11], s90 offen sc1
    v_mfma_f32_16x16x32_bf16 v[132:135], a[0:3], a[124:127], 0
    v_mfma_f32_16x16x32_bf16 v[148:151], a[4:7], a[124:127], 0
    v_mfma_f32_16x16x32_bf16 v[164:167], a[8:11], a[124:127], 0
    v_mfma_f32_16x16x32_bf16 v[180:183], a[12:15], a[124:127], 0
    buffer_load_dwordx4 a[172:175], v8, s[8:11], s90 offen sc1
    v_mfma_f32_16x16x32_bf16 v[120:123], a[16:19], a[128:131], v[120:123]
    v_mfma_f32_16x16x32_bf16 v[136:139], a[20:23], a[128:131], v[136:139]
    v_mfma_f32_16x16x32_bf16 v[152:155], a[24:27], a[128:131], v[152:155]
    v_mfma_f32_16x16x32_bf16 v[168:171], a[28:31], a[128:131], v[168:171]
    buffer_load_dwordx4 a[176:179], v5, s[8:11], s91 offen sc1
    v_mfma_f32_16x16x32_bf16 v[124:127], a[16:19], a[132:135], v[124:127]
    v_mfma_f32_16x16x32_bf16 v[140:143], a[20:23], a[132:135], v[140:143]
    v_mfma_f32_16x16x32_bf16 v[156:159], a[24:27], a[132:135], v[156:159]
    v_mfma_f32_16x16x32_bf16 v[172:175], a[28:31], a[132:135], v[172:175]
    buffer_load_dwordx4 a[180:183], v6, s[8:11], s91 offen sc1
    v_mfma_f32_16x16x32_bf16 v[128:131], a[16:19], a[136:139], v[128:131]
    v_mfma_f32_16x16x32_bf16 v[144:147], a[20:23], a[136:139], v[144:147]
    v_mfma_f32_16x16x32_bf16 v[160:163], a[24:27], a[136:139], v[160:163]
    v_mfma_f32_16x16x32_bf16 v[176:179], a[28:31], a[136:139], v[176:179]
    buffer_load_dwordx4 a[184:187], v7, s[8:11], s91 offen sc1
    v_mfma_f32_16x16x32_bf16 v[132:135], a[16:19], a[140:143], v[132:135]
    v_mfma_f32_16x16x32_bf16 v[148:151], a[20:23], a[140:143], v[148:151]
    v_mfma_f32_16x16x32_bf16 v[164:167], a[24:27], a[140:143], v[164:167]
    v_mfma_f32_16x16x32_bf16 v[180:183], a[28:31], a[140:143], v[180:183]
    buffer_load_dwordx4 a[188:191], v8, s[8:11], s91 offen sc1
    s_waitcnt vmcnt(14)
    v_mfma_f32_16x16x32_bf16 v[120:123], a[32:35], a[144:147], v[120:123]
    s_waitcnt vmcnt(10)
    ds_read_b64_tr_b16 v[80:81], v21 offset:0
    v_mfma_f32_16x16x32_bf16 v[136:139], a[36:39], a[144:147], v[136:139]
    ds_read_b64_tr_b16 v[82:83], v21 offset:256
    v_mfma_f32_16x16x32_bf16 v[152:155], a[40:43], a[144:147], v[152:155]
    ds_read_b64_tr_b16 v[84:85], v21 offset:2048
    v_mfma_f32_16x16x32_bf16 v[168:171], a[44:47], a[144:147], v[168:171]
    ds_read_b64_tr_b16 v[86:87], v21 offset:2304
    buffer_load_dwordx4 a[192:195], v5, s[8:11], s92 offen sc1
    v_mfma_f32_16x16x32_bf16 v[124:127], a[32:35], a[148:151], v[124:127]
    ds_read_b64_tr_b16 v[88:89], v21 offset:8
    v_mfma_f32_16x16x32_bf16 v[140:143], a[36:39], a[148:151], v[140:143]
    ds_read_b64_tr_b16 v[90:91], v21 offset:264
    v_mfma_f32_16x16x32_bf16 v[156:159], a[40:43], a[148:151], v[156:159]
    ds_read_b64_tr_b16 v[92:93], v21 offset:2056
    v_mfma_f32_16x16x32_bf16 v[172:175], a[44:47], a[148:151], v[172:175]
    ds_read_b64_tr_b16 v[94:95], v21 offset:2312
    buffer_load_dwordx4 a[196:199], v6, s[8:11], s92 offen sc1
    v_mfma_f32_16x16x32_bf16 v[128:131], a[32:35], a[152:155], v[128:131]
    v_mfma_f32_16x16x32_bf16 v[144:147], a[36:39], a[152:155], v[144:147]
    v_mfma_f32_16x16x32_bf16 v[160:163], a[40:43], a[152:155], v[160:163]
    v_mfma_f32_16x16x32_bf16 v[176:179], a[44:47], a[152:155], v[176:179]
    buffer_load_dwordx4 a[200:203], v7, s[8:11], s92 offen sc1
    v_mfma_f32_16x16x32_bf16 v[132:135], a[32:35], a[156:159], v[132:135]
    v_mfma_f32_16x16x32_bf16 v[148:151], a[36:39], a[156:159], v[148:151]
    v_mfma_f32_16x16x32_bf16 v[164:167], a[40:43], a[156:159], v[164:167]
    v_mfma_f32_16x16x32_bf16 v[180:183], a[44:47], a[156:159], v[180:183]
    buffer_load_dwordx4 a[204:207], v8, s[8:11], s92 offen sc1
    s_waitcnt vmcnt(11)
    v_mfma_f32_16x16x32_bf16 v[120:123], a[48:51], a[160:163], v[120:123]
    s_waitcnt lgkmcnt(0)
    v_xor_b32 v96, 0x80008000, v84
    v_mfma_f32_16x16x32_bf16 v[136:139], a[52:55], a[160:163], v[136:139]
    v_xor_b32 v97, 0x80008000, v85
    v_mfma_f32_16x16x32_bf16 v[152:155], a[56:59], a[160:163], v[152:155]
    v_xor_b32 v98, 0x80008000, v86
    v_mfma_f32_16x16x32_bf16 v[168:171], a[60:63], a[160:163], v[168:171]
    v_xor_b32 v99, 0x80008000, v87
    buffer_load_dwordx4 a[208:211], v5, s[8:11], s93 offen sc1
    s_waitcnt vmcnt(11)
    v_mfma_f32_16x16x32_bf16 v[124:127], a[48:51], a[164:167], v[124:127]
    v_xor_b32 v100, 0x80008000, v88
    v_mfma_f32_16x16x32_bf16 v[140:143], a[52:55], a[164:167], v[140:143]
    v_xor_b32 v101, 0x80008000, v89
    v_mfma_f32_16x16x32_bf16 v[156:159], a[56:59], a[164:167], v[156:159]
    v_xor_b32 v102, 0x80008000, v90
    v_mfma_f32_16x16x32_bf16 v[172:175], a[60:63], a[164:167], v[172:175]
    v_xor_b32 v103, 0x80008000, v91
    buffer_load_dwordx4 a[212:215], v6, s[8:11], s93 offen sc1
    s_waitcnt vmcnt(11)
    v_mfma_f32_16x16x32_bf16 v[128:131], a[48:51], a[168:171], v[128:131]
    v_xor_b32 v104, 0x80008000, v92
    v_mfma_f32_16x16x32_bf16 v[144:147], a[52:55], a[168:171], v[144:147]
    v_xor_b32 v105, 0x80008000, v93
    v_mfma_f32_16x16x32_bf16 v[160:163], a[56:59], a[168:171], v[160:163]
    v_xor_b32 v106, 0x80008000, v94
    v_mfma_f32_16x16x32_bf16 v[176:179], a[60:63], a[168:171], v[176:179]
    v_xor_b32 v107, 0x80008000, v95
    buffer_load_dwordx4 a[216:219], v7, s[8:11], s93 offen sc1
    s_waitcnt vmcnt(11)
    v_mfma_f32_16x16x32_bf16 v[132:135], a[48:51], a[172:175], v[132:135]
    v_mfma_f32_16x16x32_bf16 v[148:151], a[52:55], a[172:175], v[148:151]
    v_mfma_f32_16x16x32_bf16 v[164:167], a[56:59], a[172:175], v[164:167]
    v_mfma_f32_16x16x32_bf16 v[180:183], a[60:63], a[172:175], v[180:183]
    buffer_load_dwordx4 a[220:223], v8, s[8:11], s93 offen sc1
    v_mfma_f32_16x16x32_bf16 v[22:25], v[80:83], a[224:227], 0
    v_mfma_f32_16x16x32_bf16 v[26:29], v[88:91], a[224:227], 0
    v_mfma_f32_16x16x32_bf16 v[30:33], v[80:83], a[232:235], 0
    v_mfma_f32_16x16x32_bf16 v[34:37], v[88:91], a[232:235], 0
    v_mfma_f32_16x16x32_bf16 v[38:41], v[80:83], a[240:243], 0
    v_mfma_f32_16x16x32_bf16 v[42:45], v[88:91], a[240:243], 0
    v_mfma_f32_16x16x32_bf16 v[46:49], v[80:83], a[248:251], 0
    v_mfma_f32_16x16x32_bf16 v[50:53], v[88:91], a[248:251], 0
    v_mfma_f32_16x16x32_bf16 v[22:25], v[84:87], a[224:227], v[22:25]
    v_mfma_f32_16x16x32_bf16 v[26:29], v[92:95], a[224:227], v[26:29]
    v_mfma_f32_16x16x32_bf16 v[30:33], v[84:87], a[232:235], v[30:33]
    v_mfma_f32_16x16x32_bf16 v[34:37], v[92:95], a[232:235], v[34:37]
    v_mfma_f32_16x16x32_bf16 v[38:41], v[96:99], a[240:243], v[38:41]
    v_mfma_f32_16x16x32_bf16 v[42:45], v[104:107], a[240:243], v[42:45]
    v_mfma_f32_16x16x32_bf16 v[46:49], v[96:99], a[248:251], v[46:49]
    v_mfma_f32_16x16x32_bf16 v[50:53], v[104:107], a[248:251], v[50:53]
    v_mfma_f32_16x16x32_bf16 v[22:25], v[100:103], a[228:231], v[22:25]
    v_mfma_f32_16x16x32_bf16 v[26:29], v[80:83], a[228:231], v[26:29]
    v_mfma_f32_16x16x32_bf16 v[30:33], v[100:103], a[236:239], v[30:33]
    v_mfma_f32_16x16x32_bf16 v[34:37], v[80:83], a[236:239], v[34:37]
    v_mfma_f32_16x16x32_bf16 v[38:41], v[100:103], a[244:247], v[38:41]
    v_mfma_f32_16x16x32_bf16 v[42:45], v[80:83], a[244:247], v[42:45]
    v_mfma_f32_16x16x32_bf16 v[46:49], v[100:103], a[252:255], v[46:49]
    v_mfma_f32_16x16x32_bf16 v[50:53], v[80:83], a[252:255], v[50:53]
    v_mfma_f32_16x16x32_bf16 v[22:25], v[104:107], a[228:231], v[22:25]
    v_mfma_f32_16x16x32_bf16 v[26:29], v[84:87], a[228:231], v[26:29]
    v_mfma_f32_16x16x32_bf16 v[30:33], v[104:107], a[236:239], v[30:33]
    v_mfma_f32_16x16x32_bf16 v[34:37], v[84:87], a[236:239], v[34:37]
    v_mfma_f32_16x16x32_bf16 v[38:41], v[92:95], a[244:247], v[38:41]
    v_mfma_f32_16x16x32_bf16 v[42:45], v[96:99], a[244:247], v[42:45]
    v_mfma_f32_16x16x32_bf16 v[46:49], v[92:95], a[252:255], v[46:49]
    v_mfma_f32_16x16x32_bf16 v[50:53], v[96:99], a[252:255], v[50:53]
    s_lshl_b32 s66, s2, 6
    s_lshl_b32 s67, s48, 4
    s_add_u32 s66, s66, s67
    s_add_u32 s66, s66, 17874944
    s_mov_b32 s98, s101
    s_atomic_swap s98, s[8:9], s66 glc
    s_waitcnt vmcnt(11)
    v_mfma_f32_16x16x32_bf16 v[120:123], a[64:67], a[176:179], v[120:123]
    s_lshl_b32 s66, s48, 13
    v_mfma_f32_16x16x32_bf16 v[136:139], a[68:71], a[176:179], v[136:139]
    s_add_u32 s66, s66, 98304
    v_mfma_f32_16x16x32_bf16 v[152:155], a[72:75], a[176:179], v[152:155]
    v_add_u32 v9, s66, v3
    v_mfma_f32_16x16x32_bf16 v[168:171], a[76:79], a[176:179], v[168:171]
    ds_write_b128 v9, v[22:25] offset:0
    s_waitcnt vmcnt(10)
    v_mfma_f32_16x16x32_bf16 v[124:127], a[64:67], a[180:183], v[124:127]
    ds_write_b128 v9, v[26:29] offset:1024
    v_mfma_f32_16x16x32_bf16 v[140:143], a[68:71], a[180:183], v[140:143]
    ds_write_b128 v9, v[30:33] offset:2048
    v_mfma_f32_16x16x32_bf16 v[156:159], a[72:75], a[180:183], v[156:159]
    ds_write_b128 v9, v[34:37] offset:3072
    v_mfma_f32_16x16x32_bf16 v[172:175], a[76:79], a[180:183], v[172:175]
    ds_write_b128 v9, v[38:41] offset:4096
    s_waitcnt vmcnt(9)
    v_mfma_f32_16x16x32_bf16 v[128:131], a[64:67], a[184:187], v[128:131]
    ds_write_b128 v9, v[42:45] offset:5120
    v_mfma_f32_16x16x32_bf16 v[144:147], a[68:71], a[184:187], v[144:147]
    ds_write_b128 v9, v[46:49] offset:6144
    v_mfma_f32_16x16x32_bf16 v[160:163], a[72:75], a[184:187], v[160:163]
    ds_write_b128 v9, v[50:53] offset:7168
    v_mfma_f32_16x16x32_bf16 v[176:179], a[76:79], a[184:187], v[176:179]
    s_waitcnt vmcnt(8)
    v_mfma_f32_16x16x32_bf16 v[132:135], a[64:67], a[188:191], v[132:135]
    v_mfma_f32_16x16x32_bf16 v[148:151], a[68:71], a[188:191], v[148:151]
    v_mfma_f32_16x16x32_bf16 v[164:167], a[72:75], a[188:191], v[164:167]
    v_mfma_f32_16x16x32_bf16 v[180:183], a[76:79], a[188:191], v[180:183]
    s_waitcnt vmcnt(7)
    v_mfma_f32_16x16x32_bf16 v[120:123], a[80:83], a[192:195], v[120:123]
    v_mfma_f32_16x16x32_bf16 v[136:139], a[84:87], a[192:195], v[136:139]
    v_mfma_f32_16x16x32_bf16 v[152:155], a[88:91], a[192:195], v[152:155]
    v_mfma_f32_16x16x32_bf16 v[168:171], a[92:95], a[192:195], v[168:171]
    s_waitcnt vmcnt(6)
    v_mfma_f32_16x16x32_bf16 v[124:127], a[80:83], a[196:199], v[124:127]
    v_mfma_f32_16x16x32_bf16 v[140:143], a[84:87], a[196:199], v[140:143]
    v_mfma_f32_16x16x32_bf16 v[156:159], a[88:91], a[196:199], v[156:159]
    v_mfma_f32_16x16x32_bf16 v[172:175], a[92:95], a[196:199], v[172:175]
    s_waitcnt vmcnt(5)
    v_mfma_f32_16x16x32_bf16 v[128:131], a[80:83], a[200:203], v[128:131]
    v_mfma_f32_16x16x32_bf16 v[144:147], a[84:87], a[200:203], v[144:147]
    v_mfma_f32_16x16x32_bf16 v[160:163], a[88:91], a[200:203], v[160:163]
    v_mfma_f32_16x16x32_bf16 v[176:179], a[92:95], a[200:203], v[176:179]
    s_waitcnt vmcnt(4)
    v_mfma_f32_16x16x32_bf16 v[132:135], a[80:83], a[204:207], v[132:135]
    v_mfma_f32_16x16x32_bf16 v[148:151], a[84:87], a[204:207], v[148:151]
    v_mfma_f32_16x16x32_bf16 v[164:167], a[88:91], a[204:207], v[164:167]
    v_mfma_f32_16x16x32_bf16 v[180:183], a[92:95], a[204:207], v[180:183]
    s_xor_b32 s79, s2, 1
    s_lshl_b32 s66, s79, 6
    s_lshl_b32 s67, s48, 4
    s_add_u32 s66, s66, s67
    s_add_u32 s66, s66, 17874944
    s_mov_b32 s79, s66
    buffer_load_dword v20, off, s[8:11], s79 sc1
    s_waitcnt vmcnt(3)
    v_mfma_f32_16x16x32_bf16 v[124:127], a[96:99], a[212:215], v[124:127]
    v_mfma_f32_16x16x32_bf16 v[140:143], a[100:103], a[212:215], v[140:143]
    v_mfma_f32_16x16x32_bf16 v[156:159], a[104:107], a[212:215], v[156:159]
    v_mfma_f32_16x16x32_bf16 v[172:175], a[108:111], a[212:215], v[172:175]
    s_waitcnt vmcnt(2)
    v_mfma_f32_16x16x32_bf16 v[128:131], a[96:99], a[216:219], v[128:131]
    s_nop 2
    v_cvt_pk_bf16_f32 v220, v124, v125
    v_cvt_pk_bf16_f32 v221, v126, v127
    ds_write_b64 v11, v[220:221] offset:49152
    v_mfma_f32_16x16x32_bf16 v[144:147], a[100:103], a[216:219], v[144:147]
    v_cvt_pk_bf16_f32 v222, v140, v141
    v_cvt_pk_bf16_f32 v223, v142, v143
    ds_write_b64 v11, v[222:223] offset:50176
    v_mfma_f32_16x16x32_bf16 v[160:163], a[104:107], a[216:219], v[160:163]
    v_cvt_pk_bf16_f32 v220, v156, v157
    v_cvt_pk_bf16_f32 v221, v158, v159
    ds_write_b64 v11, v[220:221] offset:51200
    v_mfma_f32_16x16x32_bf16 v[176:179], a[108:111], a[216:219], v[176:179]
    v_cvt_pk_bf16_f32 v222, v172, v173
    v_cvt_pk_bf16_f32 v223, v174, v175
    ds_write_b64 v11, v[222:223] offset:52224
    s_waitcnt vmcnt(1)
    v_mfma_f32_16x16x32_bf16 v[132:135], a[96:99], a[220:223], v[132:135]
    v_cvt_pk_bf16_f32 v220, v128, v129
    v_cvt_pk_bf16_f32 v221, v130, v131
    ds_write_b64 v12, v[220:221] offset:49152
    v_mfma_f32_16x16x32_bf16 v[148:151], a[100:103], a[220:223], v[148:151]
    v_cvt_pk_bf16_f32 v222, v144, v145
    v_cvt_pk_bf16_f32 v223, v146, v147
    ds_write_b64 v12, v[222:223] offset:50176
    v_mfma_f32_16x16x32_bf16 v[164:167], a[104:107], a[220:223], v[164:167]
    v_cvt_pk_bf16_f32 v220, v160, v161
    v_cvt_pk_bf16_f32 v221, v162, v163
    ds_write_b64 v12, v[220:221] offset:51200
    v_mfma_f32_16x16x32_bf16 v[180:183], a[108:111], a[220:223], v[180:183]
    v_cvt_pk_bf16_f32 v222, v176, v177
    v_cvt_pk_bf16_f32 v223, v178, v179
    ds_write_b64 v12, v[222:223] offset:52224
    v_mfma_f32_16x16x32_bf16 v[120:123], a[96:99], a[208:211], v[120:123]
    v_cvt_pk_bf16_f32 v220, v132, v133
    v_cvt_pk_bf16_f32 v221, v134, v135
    ds_write_b64 v13, v[220:221] offset:49152
    v_mfma_f32_16x16x32_bf16 v[136:139], a[100:103], a[208:211], v[136:139]
    v_cvt_pk_bf16_f32 v222, v148, v149
    v_cvt_pk_bf16_f32 v223, v150, v151
    ds_write_b64 v13, v[222:223] offset:50176
    v_mfma_f32_16x16x32_bf16 v[152:155], a[104:107], a[208:211], v[152:155]
    v_cvt_pk_bf16_f32 v220, v164, v165
    v_cvt_pk_bf16_f32 v221, v166, v167
    ds_write_b64 v13, v[220:221] offset:51200
    v_mfma_f32_16x16x32_bf16 v[168:171], a[108:111], a[208:211], v[168:171]
    v_cvt_pk_bf16_f32 v222, v180, v181
    v_cvt_pk_bf16_f32 v223, v182, v183
    ds_write_b64 v13, v[222:223] offset:52224
    s_waitcnt vmcnt(0)
    v_cmp_ne_u32 vcc, s101, v20
    s_nop 1
    s_cbranch_vccnz L_poll_25
L_polled_26:
    s_xor_b32 s66, s2, 1
    s_lshl2_add_u32 s66, s66, s48
    s_lshl_b32 s66, s66, 11
    s_add_u32 s66, s66, 18874368
    buffer_load_dwordx2 v[190:191], v3, s[8:11], s66 offen offset:0 sc1
    buffer_load_dwordx2 v[198:199], v3, s[8:11], s66 offen offset:8 sc1
    buffer_load_dwordx2 v[206:207], v3, s[8:11], s66 offen offset:1024 sc1
    buffer_load_dwordx2 v[214:215], v3, s[8:11], s66 offen offset:1032 sc1
    s_waitcnt lgkmcnt(0)
    s_barrier
    ds_read_b128 v[184:187], v10 offset:49152
    ds_read_b64 v[188:189], v10 offset:53248
    ds_read_b128 v[192:195], v10 offset:50176
    ds_read_b64 v[196:197], v10 offset:54272
    ds_read_b128 v[200:203], v10 offset:51200
    ds_read_b64 v[204:205], v10 offset:55296
    ds_read_b128 v[208:211], v10 offset:52224
    ds_read_b64 v[212:213], v10 offset:56320
    ds_read_b128 v[22:25], v15 offset:0
    ds_read_b128 v[34:37], v15 offset:16384
    ds_read_b128 v[26:29], v15 offset:8192
    ds_read_b128 v[38:41], v15 offset:24576
    ds_read_b128 v[30:33], v15 offset:9216
    ds_read_b128 v[42:45], v15 offset:25600
    s_waitcnt lgkmcnt(12)
    v_mfma_f32_16x16x32_bf16 v[120:123], v[216:219], v[184:187], v[120:123]
    s_waitcnt lgkmcnt(10)
    v_mfma_f32_16x16x32_bf16 v[136:139], v[216:219], v[192:195], v[136:139]
    s_waitcnt lgkmcnt(8)
    v_mfma_f32_16x16x32_bf16 v[152:155], v[216:219], v[200:203], v[152:155]
    s_waitcnt lgkmcnt(6)
    v_mfma_f32_16x16x32_bf16 v[168:171], v[216:219], v[208:211], v[168:171]
    s_waitcnt vmcnt(0)
    v_mfma_f32_16x16x32_bf16 v[120:123], v[216:219], v[188:191], v[120:123]
    v_mfma_f32_16x16x32_bf16 v[136:139], v[216:219], v[196:199], v[136:139]
    v_mfma_f32_16x16x32_bf16 v[152:155], v[216:219], v[204:207], v[152:155]
    v_mfma_f32_16x16x32_bf16 v[168:171], v[216:219], v[212:215], v[168:171]
    s_waitcnt lgkmcnt(0)
    v_pk_add_f32 v[46:47], v[22:23], v[34:35]
    v_pk_add_f32 v[22:23], v[22:23], v[34:35] neg_lo:[0,1] neg_hi:[0,1]
    v_pk_add_f32 v[50:51], v[26:27], v[38:39]
    v_pk_add_f32 v[42:43], v[42:43], v[30:31] neg_lo:[0,1] neg_hi:[0,1]
    v_pk_add_f32 v[26:27], v[46:47], v[50:51]
    v_pk_add_f32 v[34:35], v[46:47], v[50:51] neg_lo:[0,1] neg_hi:[0,1]
    v_pk_add_f32 v[38:39], v[22:23], v[42:43]
    v_pk_add_f32 v[30:31], v[22:23], v[42:43] neg_lo:[0,1] neg_hi:[0,1]
    v_pk_fma_f32 v[232:233], v[26:27], v[54:55], v[232:233]
    v_pk_fma_f32 v[236:237], v[38:39], v[54:55], v[236:237]
    v_pk_fma_f32 v[240:241], v[34:35], v[54:55], v[240:241]
    v_pk_fma_f32 v[244:245], v[30:31], v[54:55], v[244:245]
    v_pk_add_f32 v[48:49], v[24:25], v[36:37]
    v_pk_add_f32 v[24:25], v[24:25], v[36:37] neg_lo:[0,1] neg_hi:[0,1]
    v_pk_add_f32 v[52:53], v[28:29], v[40:41]
    v_pk_add_f32 v[44:45], v[44:45], v[32:33] neg_lo:[0,1] neg_hi:[0,1]
    v_pk_add_f32 v[28:29], v[48:49], v[52:53]
    v_pk_add_f32 v[36:37], v[48:49], v[52:53] neg_lo:[0,1] neg_hi:[0,1]
    v_pk_add_f32 v[40:41], v[24:25], v[44:45]
    v_pk_add_f32 v[32:33], v[24:25], v[44:45] neg_lo:[0,1] neg_hi:[0,1]
    v_pk_fma_f32 v[234:235], v[28:29], v[54:55], v[234:235]
    v_pk_fma_f32 v[238:239], v[40:41], v[54:55], v[238:239]
    v_pk_fma_f32 v[242:243], v[36:37], v[54:55], v[242:243]
    v_pk_fma_f32 v[246:247], v[32:33], v[54:55], v[246:247]
    v_pk_fma_f32 v[120:121], v[120:121], v[248:249], v[232:233]
    v_pk_fma_f32 v[122:123], v[122:123], v[248:249], v[234:235]
    v_cvt_pk_bf16_f32 v24, v120, v121
    v_cvt_pk_bf16_f32 v25, v122, v123
    v_pk_fma_f32 v[136:137], v[136:137], v[248:249], v[236:237]
    v_pk_fma_f32 v[138:139], v[138:139], v[248:249], v[238:239]
    v_cvt_pk_bf16_f32 v26, v136, v137
    v_cvt_pk_bf16_f32 v27, v138, v139
    s_nop 0
    v_permlane16_swap_b32 v24, v26
    v_permlane16_swap_b32 v25, v27
    buffer_store_dwordx4 v[24:27], v14, s[40:43], s99 offen offset:0
    v_pk_fma_f32 v[152:153], v[152:153], v[248:249], v[240:241]
    v_pk_fma_f32 v[154:155], v[154:155], v[248:249], v[242:243]
    v_cvt_pk_bf16_f32 v28, v152, v153
    v_cvt_pk_bf16_f32 v29, v154, v155
    v_pk_fma_f32 v[168:169], v[168:169], v[248:249], v[244:245]
    v_pk_fma_f32 v[170:171], v[170:171], v[248:249], v[246:247]
    v_cvt_pk_bf16_f32 v30, v168, v169
    v_cvt_pk_bf16_f32 v31, v170, v171
    s_nop 0
    v_permlane16_swap_b32 v28, v30
    v_permlane16_swap_b32 v29, v31
    buffer_store_dwordx4 v[28:31], v14, s[40:43], s99 offen offset:512
L_end:
    s_endpgm
L_p2special_17:
    s_nop 7
    v_pk_fma_f32 v[152:153], v[136:137], v[40:41], v[152:153]
    v_pk_fma_f32 v[156:157], v[140:141], v[40:41], v[156:157]
    v_pk_fma_f32 v[152:153], v[140:141], v[48:49], v[152:153] neg_lo:[1,0,0] neg_hi:[1,0,0]
    v_pk_fma_f32 v[156:157], v[136:137], v[48:49], v[156:157]
    v_pk_fma_f32 v[154:155], v[138:139], v[42:43], v[154:155]
    v_pk_fma_f32 v[158:159], v[142:143], v[42:43], v[158:159]
    v_pk_fma_f32 v[154:155], v[142:143], v[50:51], v[154:155] neg_lo:[1,0,0] neg_hi:[1,0,0]
    v_pk_fma_f32 v[158:159], v[138:139], v[50:51], v[158:159]
    v_pk_fma_f32 v[160:161], v[144:145], v[44:45], v[160:161]
    v_pk_fma_f32 v[164:165], v[148:149], v[44:45], v[164:165]
    v_pk_fma_f32 v[160:161], v[148:149], v[52:53], v[160:161] neg_lo:[1,0,0] neg_hi:[1,0,0]
    v_pk_fma_f32 v[164:165], v[144:145], v[52:53], v[164:165]
    v_pk_fma_f32 v[162:163], v[146:147], v[46:47], v[162:163]
    v_pk_fma_f32 v[166:167], v[150:151], v[46:47], v[166:167]
    v_pk_fma_f32 v[162:163], v[150:151], v[54:55], v[162:163] neg_lo:[1,0,0] neg_hi:[1,0,0]
    v_pk_fma_f32 v[166:167], v[146:147], v[54:55], v[166:167]
    s_branch L_p2join_16
L_poll_6:
    s_mov_b32 s65, 0x8000
L_spin_27:
    s_sleep 2
    buffer_load_dword v21, off, s[44:47], 0 sc1
    s_waitcnt vmcnt(0)
    v_cmp_eq_u32 vcc, 0, v21
    s_nop 1
    s_cbranch_vccz L_polled_7
    s_sub_u32 s65, s65, 1
    s_cmp_lg_u32 s65, 0
    s_cbranch_scc1 L_spin_27
    s_branch L_polled_7
L_poll_10:
    s_mov_b32 s65, 0x8000
L_spin_28:
    s_sleep 2
    buffer_load_dword v39, v38, s[8:11], s79 offen sc1
    s_waitcnt vmcnt(0)
    v_cmp_ne_u32 vcc, s101, v39
    s_nop 1
    s_cbranch_vccz L_polled_11
    s_sub_u32 s65, s65, 1
    s_cmp_lg_u32 s65, 0
    s_cbranch_scc1 L_spin_28
    s_branch L_polled_11
L_poll_13:
    s_mov_b32 s65, 0x8000
L_spin_29:
    s_sleep 2
    buffer_load_dword v13, v12, s[8:11], s75 offen sc1
    s_waitcnt vmcnt(0)
    v_cmp_ne_u32 vcc, s101, v13
    s_nop 1
    s_cbranch_vccz L_polled_14
    s_sub_u32 s65, s65, 1
    s_cmp_lg_u32 s65, 0
    s_cbranch_scc1 L_spin_29
    s_branch L_polled_14
L_poll_19:
    s_mov_b32 s65, 0x8000
L_spin_30:
    s_sleep 2
    buffer_load_dword v20, v19, s[8:11], s79 offen sc1
    s_waitcnt vmcnt(0)
    v_cmp_ne_u32 vcc, s101, v20
    s_nop 1
    s_cbranch_vccz L_polled_20
    s_sub_u32 s65, s65, 1
    s_cmp_lg_u32 s65, 0
    s_cbranch_scc1 L_spin_30
    s_branch L_polled_20
L_poll_22:
    s_mov_b32 s65, 0x8000
L_spin_31:
    s_sleep 2
    buffer_load_dword v18, v17, s[8:11], s78 offen sc1
    s_waitcnt vmcnt(0)
    v_cmp_ne_u32 vcc, s101, v18
    s_nop 1
    s_cbranch_vccz L_polled_23
    s_sub_u32 s65, s65, 1
    s_cmp_lg_u32 s65, 0
    s_cbranch_scc1 L_spin_31
    s_branch L_polled_23
L_poll_25:
    s_mov_b32 s65, 0x8000
L_spin_32:
    s_sleep 2
    buffer_load_dword v20, off, s[8:11], s79 sc1
    s_waitcnt vmcnt(0)
    v_cmp_ne_u32 vcc, s101, v20
    s_nop 1
    s_cbranch_vccz L_polled_26
    s_sub_u32 s65, s65, 1
    s_cmp_lg_u32 s65, 0
    s_cbranch_scc1 L_spin_32
    s_branch L_polled_26
L_code_end:
    s_endpgm
.section .rodata,"a"
.p2align 6
.amdhsa_kernel gated_mix__spectral_gfnet__dense_activation_gelu__prompt_kernel
  .amdhsa_next_free_vgpr 512
  .amdhsa_next_free_sgpr 102
  .amdhsa_accum_offset 256
  .amdhsa_group_segment_fixed_size 0
  .amdhsa_kernarg_size 96
  .amdhsa_user_sgpr_count 2
  .amdhsa_user_sgpr_kernarg_segment_ptr 1
  .amdhsa_system_sgpr_workgroup_id_x 1
  .amdhsa_float_denorm_mode_32 3
.end_amdhsa_kernel
```
